```python
import torch

def _softmax(x, axis=-1):
    return torch.softmax(x, dim=axis)
def _gelu(x):
    return torch.nn.functional.gelu(x, approximate="tanh")
def _silu(x):
    return torch.nn.functional.silu(x)
def _sigmoid(x):
    return torch.sigmoid(x)
def _layernorm(x, axis=-1, eps=1e-5):
    m = x.mean(dim=axis, keepdim=True)
    v = x.var(dim=axis, keepdim=True, unbiased=False)
    return (x - m) / torch.sqrt(v + eps)
def _scatter_add(tgt, idx, src, axis=0):
    return tgt.clone().index_add_(axis, idx, src)
def _segment_sum(src, seg, n):
    out = torch.zeros((n,) + src.shape[1:], dtype=src.dtype)
    return out.index_add_(0, seg, src)
def _pad(x, pw):
    flat = tuple(v for pair in reversed(pw) for v in pair)
    return torch.nn.functional.pad(x, flat)

kernel_name = 'gather_scatter__edge_featured_mpnn_mpnn__graph'

def setup_inputs():

    _w = (lambda a: (lambda t: t.to(torch.bfloat16) if t.is_floating_point() else t)(torch.as_tensor(a)))
    N, deg, D, De = 10000, 64, 64, max(4, 1)
    E = N * deg
    H = 2 * D
    return {
        "x": _w((lambda *s: torch.randn(*s, dtype=torch.bfloat16) * 0.05)(N, D)),
        "e_attr": _w((lambda *s: torch.randn(*s, dtype=torch.bfloat16) * 1.6)(E, De)),
        "src": _w((lambda lo, hi, *s: torch.randint(lo, hi, s))(0, N, E).to(torch.int64)),
        "dst": _w((lambda lo, hi, *s: torch.randint(lo, hi, s))(0, N, E).to(torch.int64)),
        "w1": _w((lambda *s: torch.randn(*s, dtype=torch.bfloat16) * 1.6)(2 * D + De, H) * (1.0 / (2 * D + De) ** 0.5)),
        "b1": _w((lambda *s: torch.randn(*s, dtype=torch.bfloat16) * 3.2)(H) * 0.01),
        "w2": _w((lambda *s: torch.randn(*s, dtype=torch.bfloat16) * 0.05)(H, D) * (1.0 / H ** 0.5)),
        "b2": _w((lambda *s: torch.randn(*s, dtype=torch.bfloat16) * 0.05)(D) * 0.01),
    }

def reference(x, e_attr, src, dst, w1, b1, w2, b2):
    N, D = x.shape
    h_src = x[src]
    h_dst = x[dst]
    m_in = torch.concatenate([h_src, h_dst, e_attr], axis=-1)
    h = _silu(m_in @ w1 + b1)
    msg = h @ w2 + b2
    return _segment_sum(msg, dst, N)
```

```asm
; @launch grid=(256,1,1) block=(512,1,1) lds=163072
.amdgcn_target "amdgcn-amd-amdhsa--gfx950"
.text
.globl gather_scatter__edge_featured_mpnn_mpnn__graph_kernel
.p2align 8
.type gather_scatter__edge_featured_mpnn_mpnn__graph_kernel,@function
gather_scatter__edge_featured_mpnn_mpnn__graph_kernel:
    s_cmp_ge_u32 s2, 256
    s_cbranch_scc1 K2_exit
    s_load_dwordx8 s[4:11], s[0:1], 0
    s_load_dwordx8 s[64:71], s[0:1], 32
    s_load_dwordx2 s[72:73], s[0:1], 64
    s_load_dwordx2 s[12:13], s[0:1], 80
    s_getpc_b64 s[74:75]
K_pc:
    v_lshlrev_b32 v198, 7, v0
    v_mov_b32 v197, s75
    v_add_co_u32 v196, vcc, s74, v198
    s_nop 1
    v_addc_co_u32 v197, vcc, 0, v197, vcc
    v_cmp_gt_u32 vcc, K2_hot_end-K_pc, v198
    s_mov_b64 exec, vcc
    s_cbranch_execz K_nopf
    global_load_dword v38, v[196:197], off
K_nopf:
    s_mov_b64 exec, -1
    s_setprio 3
    v_lshlrev_b32 v198, 2, v0
    v_mov_b32 v199, 0
    v_readfirstlane_b32 s44, v0
    ds_write_b32 v198, v199 offset:36096
    s_and_b32 s3, s2, 7
    s_lshl_b32 s3, s3, 5
    s_lshr_b32 s14, s2, 3
    s_add_u32 s3, s3, s14
    s_mul_i32 s55, s3, 625
    s_add_u32 s97, s55, 640
    s_add_u32 s55, s55, 15
    s_lshr_b32 s55, s55, 4
    s_lshr_b32 s97, s97, 4
    s_sub_u32 s97, s97, s55
    s_lshl_b32 s3, s3, 3
    s_add_u32 s3, s3, 7798784
    s_lshr_b32 s44, s44, 6
    v_and_b32 v1, 63, v0
    v_lshlrev_b32 v7, 4, v1
    v_lshlrev_b32 v200, 3, v0
    v_lshlrev_b32 v201, 4, v0
    s_mul_i32 s53, s2, 10240
    v_lshrrev_b32 v8, 3, v0
    s_cmp_lt_u32 s44, 5
    s_cselect_b32 s54, s55, 10000
    v_add_u32 v8, s54, v8
    v_bfe_u32 v9, v0, 4, 3
    v_and_b32 v10, 7, v0
    v_xor_b32 v9, v9, v10
    v_lshlrev_b32 v9, 4, v9
    s_lshl_b32 s54, s44, 10
    s_add_u32 s54, s54, 11520
    s_mov_b32 m0, s54
    v_and_b32 v2, 31, v0
    v_lshlrev_b32 v251, 1, v2
    v_lshlrev_b32 v2, 2, v2
    s_cmp_lt_u32 s2, 250
    s_cselect_b64 s[88:89], -1, 0
    s_cmp_lt_u32 s44, 4
    s_cselect_b64 s[90:91], s[88:89], 0
    s_waitcnt lgkmcnt(0)
    s_mov_b32 s76, s10
    s_and_b32 s77, s11, 0xffff
    s_mov_b32 s78, 2560000
    s_mov_b32 s79, 0x20000
    s_add_u32 s92, s53, 4096
    s_add_u32 s93, s53, 8192
    buffer_load_dwordx2 v[144:145], v200, s[76:79], s53 offen
    buffer_load_dwordx2 v[146:147], v200, s[76:79], s92 offen
    s_mov_b64 exec, s[90:91]
    buffer_load_dwordx2 v[148:149], v200, s[76:79], s93 offen
    s_mov_b64 exec, -1
    s_add_u32 s36, s12, 7749632
    s_addc_u32 s37, s13, 0
    s_load_dwordx2 s[40:41], s[36:37], 0
    s_mov_b32 s76, s8
    s_and_b32 s77, s9, 0xffff
    s_mov_b32 s78, 2560000
    s_mov_b32 s79, 0x20000
    s_mov_b32 s80, s6
    s_and_b32 s81, s7, 0xffff
    s_mov_b32 s82, 5120000
    s_mov_b32 s83, 0x20000
    s_lshl_b32 s54, s53, 1
    s_add_u32 s94, s54, 8192
    s_add_u32 s95, s54, 16384
    s_mov_b32 s28, s4
    s_and_b32 s29, s5, 0xffff
    s_or_b32 s29, s29, 0x800000
    s_mov_b32 s30, 10000
    s_mov_b32 s31, 0x20000
    buffer_load_dwordx4 v[8:9], s[28:31], 0 idxen offen lds
    s_mov_b32 s28, s64
    s_and_b32 s29, s65, 0xffff
    s_mov_b32 s30, 33792
    s_mov_b32 s31, 0x20000
    s_lshl_b32 s43, s44, 11
    s_add_u32 s14, s43, 79104
    s_mov_b32 m0, s14
    s_and_b32 s15, s44, 1
    buffer_load_dwordx4 v7, s[28:31], s43 offen offset:0 lds
    buffer_load_dwordx4 v7, s[28:31], s43 offen offset:1024 lds
    s_lshl_b32 s15, s15, 7
    s_barrier
    buffer_load_dwordx2 v[150:151], v200, s[76:79], s53 offen
    buffer_load_dwordx2 v[152:153], v200, s[76:79], s92 offen
    buffer_load_dwordx4 v[156:159], v201, s[80:83], s54 offen
    buffer_load_dwordx4 v[160:163], v201, s[80:83], s94 offen
    s_mov_b64 exec, s[90:91]
    buffer_load_dwordx2 v[154:155], v200, s[76:79], s93 offen
    buffer_load_dwordx4 v[164:167], v201, s[80:83], s95 offen
    s_mov_b64 exec, -1
    s_add_u32 s24, s12, s3
    s_addc_u32 s25, s13, 0
    s_and_b32 s25, s25, 0xffff
    s_mov_b32 s26, 554888
    s_mov_b32 s27, 0x20000
    s_mov_b32 s20, s12
    s_and_b32 s21, s13, 0xffff
    s_mov_b32 s22, 7712000
    s_mov_b32 s23, 0x20000
    s_add_u32 s16, s12, 8385536
    s_addc_u32 s17, s13, 0
    s_and_b32 s17, s17, 0xffff
    s_or_b32 s17, s17, 0x1000000
    s_mov_b32 s18, 10000
    s_mov_b32 s19, 0x20000
    s_mov_b32 s32, s72
    s_and_b32 s33, s73, 0xffff
    s_mov_b32 s34, 1280000
    s_mov_b32 s35, 0x20000
    s_and_b32 s37, s37, 0xffff
    s_mov_b32 s38, 8192
    s_mov_b32 s39, 0x20000
    s_add_u32 s76, s12, 7750656
    s_addc_u32 s77, s13, 0
    s_and_b32 s77, s77, 0xffff
    s_mov_b32 s78, 637952
    s_mov_b32 s79, 0x20000
    s_lshl_b32 s3, s55, 8
    s_add_u32 s3, s3, 8388608
    s_add_u32 s80, s12, s3
    s_addc_u32 s81, s13, 0
    s_and_b32 s81, s81, 0xffff
    s_mov_b32 s82, 0
    s_mov_b32 s83, 0x20000
    s_lshl_b32 s82, s97, 8
    v_mov_b32 v203, 4
    s_movk_i32 s84, 625
    s_mov_b32 s96, 0xbfb8aa3b
    s_mov_b32 s85, 0x05040100
    s_mov_b32 s86, 0x07060302
    v_bfe_u32 v9, v0, 5, 1
    v_bfe_u32 v10, v0, 1, 3
    v_xor_b32 v10, v10, v9
    s_bfe_u32 s87, s44, 0x10001
    s_lshl_b32 s14, s87, 12
    v_lshl_add_u32 v8, v2, 5, s14
    v_xor_b32 v12, 0, v10
    v_lshl_add_u32 v12, v12, 4, v8
    v_xor_b32 v13, 2, v10
    v_lshl_add_u32 v13, v13, 4, v8
    v_xor_b32 v14, 4, v10
    v_lshl_add_u32 v14, v14, 4, v8
    v_xor_b32 v15, 6, v10
    v_lshl_add_u32 v15, v15, 4, v8
    s_mov_b64 s[12:13], s[70:71]
    s_waitcnt vmcnt(9)
    v_mul_u32_u24 v168, 214749, v144
    v_lshrrev_b32 v168, 23, v168
    v_mad_u32_u24 v180, v168, s84, 15
    v_lshlrev_b32 v168, 2, v168
    v_mul_u32_u24 v169, 214749, v145
    v_lshrrev_b32 v169, 23, v169
    v_mad_u32_u24 v181, v169, s84, 15
    v_lshlrev_b32 v169, 2, v169
    v_mul_u32_u24 v170, 214749, v146
    v_lshrrev_b32 v170, 23, v170
    v_mad_u32_u24 v182, v170, s84, 15
    v_lshlrev_b32 v170, 2, v170
    v_mul_u32_u24 v171, 214749, v147
    v_lshrrev_b32 v171, 23, v171
    v_mad_u32_u24 v183, v171, s84, 15
    v_lshlrev_b32 v171, 2, v171
    v_mul_u32_u24 v172, 214749, v148
    v_lshrrev_b32 v172, 23, v172
    v_mad_u32_u24 v184, v172, s84, 15
    v_lshlrev_b32 v172, 2, v172
    v_mul_u32_u24 v173, 214749, v149
    v_lshrrev_b32 v173, 23, v173
    v_mad_u32_u24 v185, v173, s84, 15
    v_lshlrev_b32 v173, 2, v173
    s_mov_b64 exec, s[88:89]
    ds_add_rtn_u32 v174, v168, v203 offset:36096
    ds_add_rtn_u32 v175, v169, v203 offset:36096
    ds_add_rtn_u32 v176, v170, v203 offset:36096
    ds_add_rtn_u32 v177, v171, v203 offset:36096
    s_mov_b64 exec, s[90:91]
    ds_add_rtn_u32 v178, v172, v203 offset:36096
    ds_add_rtn_u32 v179, v173, v203 offset:36096
    s_mov_b64 exec, -1
    v_lshrrev_b32 v180, 4, v180
    v_sub_u32 v180, v144, v180
    v_lshrrev_b32 v181, 4, v181
    v_sub_u32 v181, v145, v181
    v_lshrrev_b32 v182, 4, v182
    v_sub_u32 v182, v146, v182
    v_lshrrev_b32 v183, 4, v183
    v_sub_u32 v183, v147, v183
    v_lshrrev_b32 v184, 4, v184
    v_sub_u32 v184, v148, v184
    v_lshrrev_b32 v185, 4, v185
    v_sub_u32 v185, v149, v185
    s_waitcnt vmcnt(6) lgkmcnt(0)
    s_barrier
    ds_read_b128 v[188:191], v7 offset:36096
    s_add_u32 s40, s40, 1
    s_mov_b32 s42, 0xc003c003
    s_waitcnt lgkmcnt(0)
    v_add_u32 v196, v188, v189
    v_add3_u32 v196, v196, v190, v191
    v_mov_b32 v197, v196
    s_nop 1
    v_add_u32_dpp v197, v197, v197 row_shr:1 row_mask:0xf bank_mask:0xf bound_ctrl:0
    s_nop 1
    v_add_u32_dpp v197, v197, v197 row_shr:2 row_mask:0xf bank_mask:0xf bound_ctrl:0
    s_nop 1
    v_add_u32_dpp v197, v197, v197 row_shr:4 row_mask:0xf bank_mask:0xf bound_ctrl:0
    s_nop 1
    v_add_u32_dpp v197, v197, v197 row_shr:8 row_mask:0xf bank_mask:0xf bound_ctrl:0
    s_nop 1
    v_add_u32_dpp v197, v197, v197 row_bcast:15 row_mask:0xa bank_mask:0xf
    s_nop 1
    v_add_u32_dpp v197, v197, v197 row_bcast:31 row_mask:0xc bank_mask:0xf
    v_sub_u32 v192, v197, v196
    v_add_u32 v193, v192, v188
    v_add_u32 v194, v193, v189
    v_add_u32 v195, v194, v190
    ds_write_b128 v7, v[192:195] offset:37120
    v_and_b32 v168, 0x3fc, v168
    v_and_b32 v169, 0x3fc, v169
    v_and_b32 v170, 0x3fc, v170
    v_and_b32 v171, 0x3fc, v171
    v_and_b32 v172, 0x3fc, v172
    v_and_b32 v173, 0x3fc, v173
    ds_read_b32 v168, v168 offset:37120
    ds_read_b32 v169, v169 offset:37120
    ds_read_b32 v170, v170 offset:37120
    ds_read_b32 v171, v171 offset:37120
    ds_read_b32 v172, v172 offset:37120
    ds_read_b32 v173, v173 offset:37120
    s_cmp_ge_u32 s44, 4
    s_cbranch_scc1 P1_pjob
    s_lshl_b32 s43, s44, 12
    s_add_u32 s43, s43, 16384
    s_add_u32 s14, s43, 79104
    s_mov_b32 m0, s14
    s_mov_b32 s14, 111872
    buffer_load_dwordx4 v7, s[28:31], s43 offen offset:0 lds
    buffer_load_dwordx4 v7, s[28:31], s43 offen offset:1024 lds
    buffer_load_dwordx4 v7, s[28:31], s43 offen offset:2048 lds
    buffer_load_dwordx4 v7, s[28:31], s43 offen offset:3072 lds
    s_mov_b32 m0, s14
    s_mov_b32 s54, 32768
    buffer_load_dwordx4 v7, s[28:31], s54 offen lds
    s_mov_b32 s28, s66
    s_and_b32 s29, s67, 0xffff
    s_mov_b32 s30, 256
    s_mov_b32 s31, 0x20000
    buffer_load_dword v98, v2, s[28:31], s15 offen
    s_mul_i32 s3, s2, 30848
    s_waitcnt lgkmcnt(0)
    v_add_u32 v168, v168, v174
    v_add_u32 v168, 24192, v168
    v_lshlrev_b32 v174, 1, v168
    v_add_u32 v169, v169, v175
    v_add_u32 v169, 24192, v169
    v_lshlrev_b32 v175, 1, v169
    v_add_u32 v170, v170, v176
    v_add_u32 v170, 24192, v170
    v_lshlrev_b32 v176, 1, v170
    v_add_u32 v171, v171, v177
    v_add_u32 v171, 24192, v171
    v_lshlrev_b32 v177, 1, v171
    v_add_u32 v172, v172, v178
    v_add_u32 v172, 24192, v172
    v_lshlrev_b32 v178, 1, v172
    v_add_u32 v173, v173, v179
    v_add_u32 v173, 24192, v173
    v_lshlrev_b32 v179, 1, v173
    v_add_u32 v203, 48384, v201
    s_cmp_ge_u32 s44, 2
    s_cbranch_scc1 P1_nodesc
    ds_read_b64 v[188:189], v200 offset:36096
    ds_read_b64 v[192:193], v200 offset:37120
    s_mul_i32 s14, s2, 2176
    s_add_u32 s14, s14, 48128
    v_mov_b32 v241, s40
    v_mov_b32 v243, s40
    s_waitcnt lgkmcnt(0)
    v_lshl_or_b32 v240, v188, 16, v192
    v_xor_b32 v240, s41, v240
    v_lshl_or_b32 v242, v189, 16, v193
    v_xor_b32 v242, s41, v242
    buffer_store_dwordx4 v[240:243], v201, s[76:79], s14 offen sc1
    s_waitcnt vmcnt(1)
    s_branch P1_egot
P1_nodesc:
    s_waitcnt vmcnt(0)
    s_branch P1_egot
P1_pjob:
    s_add_u32 s14, s15, 79104
    v_lshl_add_u32 v196, v9, 11, v2
    v_add_u32 v196, s14, v196
    ds_read2st64_b32 v[56:57], v196 offset0:0 offset1:1
    ds_read2st64_b32 v[58:59], v196 offset0:2 offset1:3
    ds_read2st64_b32 v[60:61], v196 offset0:4 offset1:5
    ds_read2st64_b32 v[62:63], v196 offset0:6 offset1:7
    ds_read2st64_b32 v[64:65], v196 offset0:16 offset1:17
    ds_read2st64_b32 v[66:67], v196 offset0:18 offset1:19
    ds_read2st64_b32 v[68:69], v196 offset0:20 offset1:21
    ds_read2st64_b32 v[70:71], v196 offset0:22 offset1:23
    ds_read2st64_b32 v[72:73], v196 offset0:32 offset1:33
    ds_read2st64_b32 v[74:75], v196 offset0:34 offset1:35
    ds_read2st64_b32 v[76:77], v196 offset0:36 offset1:37
    ds_read2st64_b32 v[78:79], v196 offset0:38 offset1:39
    ds_read2st64_b32 v[80:81], v196 offset0:48 offset1:49
    ds_read2st64_b32 v[82:83], v196 offset0:50 offset1:51
    ds_read2st64_b32 v[84:85], v196 offset0:52 offset1:53
    ds_read2st64_b32 v[86:87], v196 offset0:54 offset1:55
    ds_read_b128 v[220:223], v12 offset:11520
    ds_read_b128 v[224:227], v13 offset:11520
    ds_read_b128 v[228:231], v14 offset:11520
    ds_read_b128 v[232:235], v15 offset:11520
    s_lshl_b32 s14, s87, 13
    s_add_u32 s14, s14, s15
    s_add_u32 s14, s14, 19712
    v_lshl_add_u32 v196, v9, 10, v2
    v_add_u32 v196, s14, v196
    s_waitcnt lgkmcnt(4)
    v_perm_b32 v112, v57, v56, s85
    v_perm_b32 v56, v57, v56, s86
    v_perm_b32 v113, v59, v58, s85
    v_perm_b32 v57, v59, v58, s86
    v_perm_b32 v114, v61, v60, s85
    v_perm_b32 v58, v61, v60, s86
    v_perm_b32 v115, v63, v62, s85
    v_perm_b32 v59, v63, v62, s86
    v_perm_b32 v116, v65, v64, s85
    v_perm_b32 v60, v65, v64, s86
    v_perm_b32 v117, v67, v66, s85
    v_perm_b32 v61, v67, v66, s86
    v_perm_b32 v118, v69, v68, s85
    v_perm_b32 v62, v69, v68, s86
    v_perm_b32 v119, v71, v70, s85
    v_perm_b32 v63, v71, v70, s86
    v_perm_b32 v120, v73, v72, s85
    v_perm_b32 v64, v73, v72, s86
    v_perm_b32 v121, v75, v74, s85
    v_perm_b32 v65, v75, v74, s86
    v_perm_b32 v122, v77, v76, s85
    v_perm_b32 v66, v77, v76, s86
    v_perm_b32 v123, v79, v78, s85
    v_perm_b32 v67, v79, v78, s86
    v_perm_b32 v124, v81, v80, s85
    v_perm_b32 v68, v81, v80, s86
    v_perm_b32 v125, v83, v82, s85
    v_perm_b32 v69, v83, v82, s86
    v_perm_b32 v126, v85, v84, s85
    v_perm_b32 v70, v85, v84, s86
    v_perm_b32 v127, v87, v86, s85
    v_perm_b32 v71, v87, v86, s86
    s_waitcnt lgkmcnt(0)
    v_mfma_f32_32x32x16_bf16 v[72:87], v[220:223], v[112:115], 0
    v_mfma_f32_32x32x16_bf16 v[72:87], v[224:227], v[116:119], v[72:87]
    v_mfma_f32_32x32x16_bf16 v[72:87], v[228:231], v[120:123], v[72:87]
    v_mfma_f32_32x32x16_bf16 v[72:87], v[232:235], v[124:127], v[72:87]
    v_mfma_f32_32x32x16_bf16 v[112:127], v[220:223], v[56:59], 0
    v_mfma_f32_32x32x16_bf16 v[112:127], v[224:227], v[60:63], v[112:127]
    v_mfma_f32_32x32x16_bf16 v[112:127], v[228:231], v[64:67], v[112:127]
    v_mfma_f32_32x32x16_bf16 v[112:127], v[232:235], v[68:71], v[112:127]
    s_nop 11
    v_mul_f32 v72, s96, v72
    v_mul_f32 v112, s96, v112
    v_cvt_pk_bf16_f32 v220, v72, v112
    v_mul_f32 v73, s96, v73
    v_mul_f32 v113, s96, v113
    v_cvt_pk_bf16_f32 v221, v73, v113
    ds_write2st64_b32 v196, v220, v221 offset0:0 offset1:1
    v_mul_f32 v74, s96, v74
    v_mul_f32 v114, s96, v114
    v_cvt_pk_bf16_f32 v222, v74, v114
    v_mul_f32 v75, s96, v75
    v_mul_f32 v115, s96, v115
    v_cvt_pk_bf16_f32 v223, v75, v115
    ds_write2st64_b32 v196, v222, v223 offset0:2 offset1:3
    s_cmp_lg_u32 s87, 0
    s_cbranch_scc1 P1_half0
    v_mul_f32 v76, s96, v76
    v_mul_f32 v116, s96, v116
    v_cvt_pk_bf16_f32 v224, v76, v116
    v_mul_f32 v77, s96, v77
    v_mul_f32 v117, s96, v117
    v_cvt_pk_bf16_f32 v225, v77, v117
    ds_write2st64_b32 v196, v224, v225 offset0:8 offset1:9
    v_mul_f32 v78, s96, v78
    v_mul_f32 v118, s96, v118
    v_cvt_pk_bf16_f32 v226, v78, v118
    v_mul_f32 v79, s96, v79
    v_mul_f32 v119, s96, v119
    v_cvt_pk_bf16_f32 v227, v79, v119
    ds_write2st64_b32 v196, v226, v227 offset0:10 offset1:11
    v_mul_f32 v80, s96, v80
    v_mul_f32 v120, s96, v120
    v_cvt_pk_bf16_f32 v228, v80, v120
    v_mul_f32 v81, s96, v81
    v_mul_f32 v121, s96, v121
    v_cvt_pk_bf16_f32 v229, v81, v121
    ds_write2st64_b32 v196, v228, v229 offset0:16 offset1:17
    v_mul_f32 v82, s96, v82
    v_mul_f32 v122, s96, v122
    v_cvt_pk_bf16_f32 v230, v82, v122
    v_mul_f32 v83, s96, v83
    v_mul_f32 v123, s96, v123
    v_cvt_pk_bf16_f32 v231, v83, v123
    ds_write2st64_b32 v196, v230, v231 offset0:18 offset1:19
    v_mul_f32 v84, s96, v84
    v_mul_f32 v124, s96, v124
    v_cvt_pk_bf16_f32 v232, v84, v124
    v_mul_f32 v85, s96, v85
    v_mul_f32 v125, s96, v125
    v_cvt_pk_bf16_f32 v233, v85, v125
    ds_write2st64_b32 v196, v232, v233 offset0:24 offset1:25
    v_mul_f32 v86, s96, v86
    v_mul_f32 v126, s96, v126
    v_cvt_pk_bf16_f32 v234, v86, v126
    v_mul_f32 v87, s96, v87
    v_mul_f32 v127, s96, v127
    v_cvt_pk_bf16_f32 v235, v87, v127
    ds_write2st64_b32 v196, v234, v235 offset0:26 offset1:27
P1_half0:
    v_bfe_u32 v196, v0, 3, 3
    v_and_b32 v197, 7, v0
    v_lshlrev_b32 v197, 4, v197
    v_lshl_add_u32 v196, v196, 8, v197
    v_add_u32 v197, s14, v196
    ds_read_b128 v[56:59], v197 offset:0
    ds_read_b128 v[60:63], v197 offset:2048
    ds_read_b128 v[64:67], v197 offset:4096
    ds_read_b128 v[68:71], v197 offset:6144
    s_sub_u32 s14, s14, 19712
    s_add_u32 s92, s14, 4096
    s_waitcnt lgkmcnt(3)
    buffer_store_dwordx4 v[56:59], v196, s[80:83], s14 offen offset:0 sc1
    s_waitcnt lgkmcnt(2)
    buffer_store_dwordx4 v[60:63], v196, s[80:83], s14 offen offset:2048 sc1
    s_waitcnt lgkmcnt(1)
    buffer_store_dwordx4 v[64:67], v196, s[80:83], s92 offen offset:0 sc1
    s_waitcnt lgkmcnt(0)
    buffer_store_dwordx4 v[68:71], v196, s[80:83], s92 offen offset:2048 sc1
    s_mul_i32 s3, s2, 30848
    s_waitcnt lgkmcnt(0)
    v_add_u32 v168, v168, v174
    v_add_u32 v168, 24192, v168
    v_lshlrev_b32 v174, 1, v168
    v_add_u32 v169, v169, v175
    v_add_u32 v169, 24192, v169
    v_lshlrev_b32 v175, 1, v169
    v_add_u32 v170, v170, v176
    v_add_u32 v170, 24192, v170
    v_lshlrev_b32 v176, 1, v170
    v_add_u32 v171, v171, v177
    v_add_u32 v171, 24192, v171
    v_lshlrev_b32 v177, 1, v171
    v_add_u32 v172, v172, v178
    v_add_u32 v172, 24192, v172
    v_lshlrev_b32 v178, 1, v172
    v_add_u32 v173, v173, v179
    v_add_u32 v173, 24192, v173
    v_lshlrev_b32 v179, 1, v173
    v_add_u32 v203, 48384, v201
    s_waitcnt vmcnt(4)
P1_egot:
    s_mov_b32 s28, s68
    s_and_b32 s29, s69, 0xffff
    s_mov_b32 s30, 16384
    s_mov_b32 s31, 0x20000
    v_lshl_or_b32 v180, v180, 18, v150
    v_lshl_or_b32 v181, v181, 18, v151
    v_lshl_or_b32 v182, v182, 18, v152
    v_lshl_or_b32 v183, v183, 18, v153
    v_lshl_or_b32 v184, v184, 18, v154
    v_lshl_or_b32 v185, v185, 18, v155
    s_mov_b64 exec, s[88:89]
    ds_write_b64 v174, v[156:157]
    ds_write_b32 v168, v180 offset:44672
    ds_write_b64 v175, v[158:159]
    ds_write_b32 v169, v181 offset:44672
    ds_write_b64 v176, v[160:161]
    ds_write_b32 v170, v182 offset:44672
    ds_write_b64 v177, v[162:163]
    ds_write_b32 v171, v183 offset:44672
    s_mov_b64 exec, s[90:91]
    ds_write_b64 v178, v[164:165]
    ds_write_b32 v172, v184 offset:44672
    ds_write_b64 v179, v[166:167]
    ds_write_b32 v173, v185 offset:44672
    s_mov_b64 exec, -1
    v_cmp_gt_u32 vcc, 384, v0
    s_waitcnt lgkmcnt(0)
    s_barrier
    ds_read_b128 v[144:147], v203 offset:0
    ds_read_b128 v[148:151], v203 offset:8192
    ds_read_b128 v[152:155], v203 offset:16384
    ds_read_b128 v[156:159], v203 offset:24576
    s_waitcnt lgkmcnt(3)
    buffer_store_dwordx4 v[144:147], v201, s[20:23], s3 offen sc1
    s_add_u32 s3, s3, 8192
    s_waitcnt lgkmcnt(2)
    buffer_store_dwordx4 v[148:151], v201, s[20:23], s3 offen sc1
    s_add_u32 s3, s3, 8192
    s_waitcnt lgkmcnt(1)
    buffer_store_dwordx4 v[152:155], v201, s[20:23], s3 offen sc1
    s_add_u32 s3, s3, 8192
    s_waitcnt lgkmcnt(0)
    s_mov_b64 exec, vcc
    buffer_store_dwordx4 v[156:159], v201, s[20:23], s3 offen sc1
    s_mov_b64 exec, -1
    s_cmp_ge_u32 s44, 4
    s_cbranch_scc1 P1_b5
    s_add_u32 s14, s15, 95488
    v_lshl_add_u32 v196, v9, 11, v2
    v_add_u32 v196, s14, v196
    ds_read2st64_b32 v[56:57], v196 offset0:0 offset1:1
    ds_read2st64_b32 v[58:59], v196 offset0:2 offset1:3
    ds_read2st64_b32 v[60:61], v196 offset0:4 offset1:5
    ds_read2st64_b32 v[62:63], v196 offset0:6 offset1:7
    ds_read2st64_b32 v[64:65], v196 offset0:16 offset1:17
    ds_read2st64_b32 v[66:67], v196 offset0:18 offset1:19
    ds_read2st64_b32 v[68:69], v196 offset0:20 offset1:21
    ds_read2st64_b32 v[70:71], v196 offset0:22 offset1:23
    ds_read2st64_b32 v[72:73], v196 offset0:32 offset1:33
    ds_read2st64_b32 v[74:75], v196 offset0:34 offset1:35
    ds_read2st64_b32 v[76:77], v196 offset0:36 offset1:37
    ds_read2st64_b32 v[78:79], v196 offset0:38 offset1:39
    ds_read2st64_b32 v[80:81], v196 offset0:48 offset1:49
    ds_read2st64_b32 v[82:83], v196 offset0:50 offset1:51
    ds_read2st64_b32 v[84:85], v196 offset0:52 offset1:53
    ds_read2st64_b32 v[86:87], v196 offset0:54 offset1:55
    ds_read_b128 v[168:171], v12 offset:11520
    ds_read_b128 v[172:175], v13 offset:11520
    ds_read_b128 v[176:179], v14 offset:11520
    ds_read_b128 v[180:183], v15 offset:11520
    v_lshlrev_b32 v198, 16, v98
    v_and_b32 v199, 0xffff0000, v98
    v_mul_f32 v198, s96, v198
    v_mul_f32 v199, s96, v199
    s_lshl_b32 s14, s87, 13
    s_add_u32 s14, s14, s15
    v_lshl_add_u32 v196, v9, 10, v2
    v_add_u32 v196, s14, v196
    s_waitcnt lgkmcnt(4)
    v_perm_b32 v112, v57, v56, s85
    v_perm_b32 v56, v57, v56, s86
    v_perm_b32 v113, v59, v58, s85
    v_perm_b32 v57, v59, v58, s86
    v_perm_b32 v114, v61, v60, s85
    v_perm_b32 v58, v61, v60, s86
    v_perm_b32 v115, v63, v62, s85
    v_perm_b32 v59, v63, v62, s86
    v_perm_b32 v116, v65, v64, s85
    v_perm_b32 v60, v65, v64, s86
    v_perm_b32 v117, v67, v66, s85
    v_perm_b32 v61, v67, v66, s86
    v_perm_b32 v118, v69, v68, s85
    v_perm_b32 v62, v69, v68, s86
    v_perm_b32 v119, v71, v70, s85
    v_perm_b32 v63, v71, v70, s86
    v_perm_b32 v120, v73, v72, s85
    v_perm_b32 v64, v73, v72, s86
    v_perm_b32 v121, v75, v74, s85
    v_perm_b32 v65, v75, v74, s86
    v_perm_b32 v122, v77, v76, s85
    v_perm_b32 v66, v77, v76, s86
    v_perm_b32 v123, v79, v78, s85
    v_perm_b32 v67, v79, v78, s86
    v_perm_b32 v124, v81, v80, s85
    v_perm_b32 v68, v81, v80, s86
    v_perm_b32 v125, v83, v82, s85
    v_perm_b32 v69, v83, v82, s86
    v_perm_b32 v126, v85, v84, s85
    v_perm_b32 v70, v85, v84, s86
    v_perm_b32 v127, v87, v86, s85
    v_perm_b32 v71, v87, v86, s86
    s_waitcnt lgkmcnt(0)
    v_mfma_f32_32x32x16_bf16 v[72:87], v[168:171], v[112:115], 0
    v_mfma_f32_32x32x16_bf16 v[72:87], v[172:175], v[116:119], v[72:87]
    v_mfma_f32_32x32x16_bf16 v[72:87], v[176:179], v[120:123], v[72:87]
    v_mfma_f32_32x32x16_bf16 v[72:87], v[180:183], v[124:127], v[72:87]
    v_mfma_f32_32x32x16_bf16 v[112:127], v[168:171], v[56:59], 0
    v_mfma_f32_32x32x16_bf16 v[112:127], v[172:175], v[60:63], v[112:127]
    v_mfma_f32_32x32x16_bf16 v[112:127], v[176:179], v[64:67], v[112:127]
    v_mfma_f32_32x32x16_bf16 v[112:127], v[180:183], v[68:71], v[112:127]
    s_nop 11
    v_fma_f32 v72, v72, s96, v198
    v_fma_f32 v112, v112, s96, v199
    v_cvt_pk_bf16_f32 v168, v72, v112
    v_fma_f32 v73, v73, s96, v198
    v_fma_f32 v113, v113, s96, v199
    v_cvt_pk_bf16_f32 v169, v73, v113
    ds_write2st64_b32 v196, v168, v169 offset0:0 offset1:1
    v_fma_f32 v74, v74, s96, v198
    v_fma_f32 v114, v114, s96, v199
    v_cvt_pk_bf16_f32 v170, v74, v114
    v_fma_f32 v75, v75, s96, v198
    v_fma_f32 v115, v115, s96, v199
    v_cvt_pk_bf16_f32 v171, v75, v115
    ds_write2st64_b32 v196, v170, v171 offset0:2 offset1:3
    s_cmp_lg_u32 s87, 0
    s_cbranch_scc1 P1_half1
    v_fma_f32 v76, v76, s96, v198
    v_fma_f32 v116, v116, s96, v199
    v_cvt_pk_bf16_f32 v172, v76, v116
    v_fma_f32 v77, v77, s96, v198
    v_fma_f32 v117, v117, s96, v199
    v_cvt_pk_bf16_f32 v173, v77, v117
    ds_write2st64_b32 v196, v172, v173 offset0:8 offset1:9
    v_fma_f32 v78, v78, s96, v198
    v_fma_f32 v118, v118, s96, v199
    v_cvt_pk_bf16_f32 v174, v78, v118
    v_fma_f32 v79, v79, s96, v198
    v_fma_f32 v119, v119, s96, v199
    v_cvt_pk_bf16_f32 v175, v79, v119
    ds_write2st64_b32 v196, v174, v175 offset0:10 offset1:11
    v_fma_f32 v80, v80, s96, v198
    v_fma_f32 v120, v120, s96, v199
    v_cvt_pk_bf16_f32 v176, v80, v120
    v_fma_f32 v81, v81, s96, v198
    v_fma_f32 v121, v121, s96, v199
    v_cvt_pk_bf16_f32 v177, v81, v121
    ds_write2st64_b32 v196, v176, v177 offset0:16 offset1:17
    v_fma_f32 v82, v82, s96, v198
    v_fma_f32 v122, v122, s96, v199
    v_cvt_pk_bf16_f32 v178, v82, v122
    v_fma_f32 v83, v83, s96, v198
    v_fma_f32 v123, v123, s96, v199
    v_cvt_pk_bf16_f32 v179, v83, v123
    ds_write2st64_b32 v196, v178, v179 offset0:18 offset1:19
    v_fma_f32 v84, v84, s96, v198
    v_fma_f32 v124, v124, s96, v199
    v_cvt_pk_bf16_f32 v180, v84, v124
    v_fma_f32 v85, v85, s96, v198
    v_fma_f32 v125, v125, s96, v199
    v_cvt_pk_bf16_f32 v181, v85, v125
    ds_write2st64_b32 v196, v180, v181 offset0:24 offset1:25
    v_fma_f32 v86, v86, s96, v198
    v_fma_f32 v126, v126, s96, v199
    v_cvt_pk_bf16_f32 v182, v86, v126
    v_fma_f32 v87, v87, s96, v198
    v_fma_f32 v127, v127, s96, v199
    v_cvt_pk_bf16_f32 v183, v87, v127
    ds_write2st64_b32 v196, v182, v183 offset0:26 offset1:27
P1_half1:
    s_branch P1_b5d
P1_b5:
    s_lshl_b32 s14, s44, 6
    s_add_u32 s14, s14, 111616
    v_add_u32 v197, s14, v251
    ds_read_u16 v176, v197 offset:0
    ds_read_u16 v177, v197 offset:256
    ds_read_u16 v178, v197 offset:512
    ds_read_u16 v179, v197 offset:768
    v_cmp_gt_u32 vcc, 32, v1
    s_waitcnt lgkmcnt(0)
    v_lshlrev_b32 v176, 16, v176
    v_mul_f32 v176, s96, v176
    v_and_b32 v197, 0xffff0000, v176
    v_sub_f32 v176, v176, v197
    v_cndmask_b32 v176, v176, v197, vcc
    v_lshlrev_b32 v177, 16, v177
    v_mul_f32 v177, s96, v177
    v_and_b32 v197, 0xffff0000, v177
    v_sub_f32 v177, v177, v197
    v_cndmask_b32 v177, v177, v197, vcc
    v_lshlrev_b32 v178, 16, v178
    v_mul_f32 v178, s96, v178
    v_and_b32 v197, 0xffff0000, v178
    v_sub_f32 v178, v178, v197
    v_cndmask_b32 v178, v178, v197, vcc
    v_lshlrev_b32 v179, 16, v179
    v_mul_f32 v179, s96, v179
    v_and_b32 v197, 0xffff0000, v179
    v_sub_f32 v179, v179, v197
    v_cndmask_b32 v179, v179, v197, vcc
    v_cvt_pk_bf16_f32 v180, v176, v177
    v_cvt_pk_bf16_f32 v181, v178, v179
    ds_write_b64 v200, v[180:181] offset:34048
P1_b5d:
    v_lshlrev_b32 v250, 1, v9
    v_and_b32 v8, 7, v0
    v_lshlrev_b32 v23, 4, v8
    v_add_u32 v17, 0xc00, v23
    v_add_u32 v19, 0x800, v23
    v_add_u32 v21, 0x400, v23
    s_mov_b32 s56, 0x05050505
    s_mov_b32 s57, 0x50505050
    s_mov_b32 s58, 0x0a0a0a0a
    s_mov_b32 s59, 0xa0a0a0a0
    v_mov_b32 v90, 0
    v_mov_b32 v91, 0
    v_mov_b32 v94, 0
    v_mov_b32 v95, 0
    v_mov_b32 v42, 0
    v_mov_b32 v43, 0
    v_mov_b32 v46, 0
    v_mov_b32 v47, 0
    v_mov_b32 v50, 0
    v_mov_b32 v51, 0
    v_mov_b32 v54, 0
    v_mov_b32 v55, 0
    v_bfe_u32 v10, v0, 2, 1
    v_and_b32 v8, 1, v0
    v_lshl_add_u32 v248, v10, 1, v8
    v_bfe_u32 v10, v0, 3, 2
    v_lshlrev_b32 v142, 5, v10
    v_bfe_u32 v10, v0, 1, 1
    v_lshl_add_u32 v142, v10, 4, v142
    v_bfe_u32 v10, v0, 3, 1
    v_add_u32 v249, v250, v10
    v_and_b32 v143, 16, v0
    v_add_u32 v143, 8, v143
    s_mov_b32 s45, 0
    s_mov_b32 s46, 32
    s_mov_b32 s47, 1
    s_mov_b32 s48, 0
    v_lshrrev_b32 v102, 4, v0
    v_mul_u32_u24 v103, 17408, v102
    v_mul_u32_u24 v102, 246784, v102
    v_lshlrev_b32 v101, 2, v1
    s_lshl_b32 s53, s44, 11
    s_add_u32 s53, s53, 10496
    v_lshl_add_u32 v11, v9, 10, s53
    v_lshlrev_b32 v250, 1, v9
    v_mov_b32 v56, 0
    v_mov_b32 v57, 0
    v_mov_b32 v58, 0
    v_mov_b32 v59, 0
    v_lshlrev_b32 v9, 4, v0
    v_cmp_gt_u32 vcc, 32, v0
    v_mov_b32 v61, 0x3f803f80
    v_add_u32 v8, 113932, v9
    s_mov_b64 exec, vcc
    ds_write_b128 v9, v[56:59] offset:46848
    ds_write_b128 v9, v[56:59] offset:10240
    s_mov_b64 exec, -1
    ds_write_b32 v8, v61 offset:0
    ds_write_b32 v8, v61 offset:8192
    ds_write_b32 v8, v61 offset:16384
    ds_write_b32 v8, v61 offset:24576
    ds_write_b32 v8, v61 offset:32768
    ds_write_b32 v8, v61 offset:40960
    s_cmp_eq_u32 s47, 0
    s_cbranch_scc1 K2_notfirsta
    ds_write_b32 v101, v56 offset:47872
    v_mov_b32 v30, 0
    v_mov_b32 v31, 0
    v_mov_b32 v104, 0
    v_mov_b32 v105, 0
    v_mov_b32 v106, 0
    v_mov_b32 v107, 0
    v_mov_b32 v108, 0
    v_mov_b32 v109, 0
    v_mov_b32 v110, 0
    v_mov_b32 v111, 0
K2_notfirsta:
    v_and_b32 v130, 15, v0
    v_add_u32 v8, 16, v130
    v_cmp_gt_u32 vcc, s46, v130
    v_cmp_gt_u32 s[60:61], s46, v8
    v_add_lshl_u32 v130, v130, s45, 2
    v_add_u32 v8, 64, v130
    v_sub_u32 v131, -40960, v102
    v_cndmask_b32 v28, -1, v130, vcc
    v_cndmask_b32 v29, -1, v8, s[60:61]
    v_add_u32 v130, v130, v102
    v_add_u32 v130, 20480, v130
    s_mov_b32 s4, 0
    s_mov_b32 s5, 30848
    s_mov_b32 s6, 61696
    s_mov_b32 s7, 92544
    s_mov_b32 s8, 123392
    s_mov_b32 s9, 154240
    s_mov_b32 s10, 185088
    s_mov_b32 s11, 215936
    s_lshl_b32 s63, s46, 2
    s_mov_b32 s62, 0
    ds_write_b32 v101, v56 offset:47360
    ds_write_b64 v56, v[56:57] offset:48128
    v_mov_b32 v224, 252
    v_mov_b32 v208, 0
    v_mov_b32 v225, 252
    v_mov_b32 v209, 0
    v_mov_b32 v226, 252
    v_mov_b32 v210, 0
    v_mov_b32 v227, 252
    v_mov_b32 v211, 0
    v_mov_b32 v228, 252
    v_mov_b32 v212, 0
    v_mov_b32 v229, 252
    v_mov_b32 v213, 0
    v_mov_b32 v230, 252
    v_mov_b32 v214, 0
    v_mov_b32 v231, 252
    v_mov_b32 v215, 0
    v_mov_b32 v202, 0
    v_mov_b32 v206, 0
    v_mov_b32 v207, 0
    s_lshl_b32 s52, s44, 13
    s_add_u32 s52, s52, 48384
    v_bfe_u32 v13, v0, 5, 1
    v_lshl_add_u32 v12, v13, 9, s52
    v_bfe_u32 v13, v0, 3, 1
    v_lshl_add_u32 v12, v13, 7, v12
    v_bfe_u32 v13, v0, 4, 1
    v_lshl_add_u32 v12, v13, 5, v12
    v_and_b32 v13, 3, v0
    v_lshl_add_u32 v12, v13, 3, v12
    v_and_b32 v13, 4, v0
    v_cmp_ne_u32 vcc, 0, v13
    v_mov_b32 v14, 0x28040
    s_nop 0
    v_cndmask_b32 v12, v14, v12, vcc
    s_add_u32 s14, s52, 4096
    s_movk_i32 s15, 128
    v_lshlrev_b32 v198, 3, v1
    v_bfe_u32 v13, v0, 5, 1
    v_lshlrev_b32 v13, 13, v13
    v_bfe_u32 v196, v0, 4, 1
    v_lshl_add_u32 v13, v196, 10, v13
    v_bfe_u32 v196, v0, 2, 2
    v_lshl_add_u32 v13, v196, 7, v13
    v_and_b32 v196, 3, v0
    v_lshl_add_u32 v13, v196, 3, v13
    s_and_b32 s3, s44, 3
    s_lshl_b32 s3, s3, 5
    s_add_u32 s3, s3, 48384
    v_add_u32 v13, s3, v13
    s_waitcnt vmcnt(0) lgkmcnt(0)
    s_barrier
    s_cmp_lg_u32 s44, 0
    s_cbranch_scc1 P1_nopub
    v_mov_b32 v196, s40
    v_mov_b32 v197, s41
    s_mul_i32 s3, s2, 8
    s_mov_b64 exec, 1
    buffer_store_dwordx2 v[196:197], v7, s[76:79], s3 offen sc1
    s_mov_b64 exec, -1
P1_nopub:
    ds_read_b64 v[40:41], v198 offset:36096
    ds_read_b64 v[44:45], v198 offset:36608
    ds_read_b64 v[48:49], v198 offset:37120
    ds_read_b64 v[52:53], v198 offset:37632
K2_begin:
    s_mov_b32 s43, 0
K2_dpoll:
    s_movk_i32 s54, 0
    buffer_load_dwordx2 v[176:177], v103, s[24:27], s54 offen offset:0 sc1
    buffer_load_dwordx2 v[178:179], v103, s[24:27], s54 offen offset:2176 sc1
    s_movk_i32 s54, 4352
    buffer_load_dwordx2 v[180:181], v103, s[24:27], s54 offen offset:0 sc1
    buffer_load_dwordx2 v[182:183], v103, s[24:27], s54 offen offset:2176 sc1
    s_movk_i32 s54, 8704
    buffer_load_dwordx2 v[184:185], v103, s[24:27], s54 offen offset:0 sc1
    buffer_load_dwordx2 v[186:187], v103, s[24:27], s54 offen offset:2176 sc1
    s_movk_i32 s54, 13056
    buffer_load_dwordx2 v[188:189], v103, s[24:27], s54 offen offset:0 sc1
    buffer_load_dwordx2 v[190:191], v103, s[24:27], s54 offen offset:2176 sc1
    s_add_u32 s43, s43, 1
    v_mov_b32 v60, 0
    s_waitcnt vmcnt(6)
    v_xor_b32 v240, s41, v176
    v_xor_b32 v241, s41, v178
    v_xor_b32 v177, s40, v177
    v_xor_b32 v179, s40, v179
    v_or_b32 v176, v240, v241
    v_or3_b32 v60, v60, v177, v179
    v_and_or_b32 v60, v176, s42, v60
    s_waitcnt vmcnt(4)
    v_xor_b32 v242, s41, v180
    v_xor_b32 v243, s41, v182
    v_xor_b32 v181, s40, v181
    v_xor_b32 v183, s40, v183
    v_or_b32 v180, v242, v243
    v_or3_b32 v60, v60, v181, v183
    v_and_or_b32 v60, v180, s42, v60
    s_waitcnt vmcnt(2)
    v_xor_b32 v244, s41, v184
    v_xor_b32 v245, s41, v186
    v_xor_b32 v185, s40, v185
    v_xor_b32 v187, s40, v187
    v_or_b32 v184, v244, v245
    v_or3_b32 v60, v60, v185, v187
    v_and_or_b32 v60, v184, s42, v60
    s_waitcnt vmcnt(0)
    v_xor_b32 v246, s41, v188
    v_xor_b32 v247, s41, v190
    v_xor_b32 v189, s40, v189
    v_xor_b32 v191, s40, v191
    v_or_b32 v188, v246, v247
    v_or3_b32 v60, v60, v189, v191
    v_and_or_b32 v60, v188, s42, v60
    v_cmp_ne_u32 vcc, 0, v60
    s_cbranch_vccnz K2_dretry
K2_dok:
    v_cmp_lt_u32_sdwa s[64:65], v28, v240 src0_sel:DWORD src1_sel:WORD_1
    v_add_u32_sdwa v216, v240, v130 dst_sel:DWORD dst_unused:UNUSED_PAD src0_sel:WORD_0 src1_sel:DWORD
    v_cmp_lt_u32_sdwa s[66:67], v28, v241 src0_sel:DWORD src1_sel:WORD_1
    v_add_u32_sdwa v217, v241, v130 dst_sel:DWORD dst_unused:UNUSED_PAD src0_sel:WORD_0 src1_sel:DWORD
    v_cmp_lt_u32_sdwa s[68:69], v28, v242 src0_sel:DWORD src1_sel:WORD_1
    v_add_u32_sdwa v218, v242, v130 dst_sel:DWORD dst_unused:UNUSED_PAD src0_sel:WORD_0 src1_sel:DWORD
    v_cmp_lt_u32_sdwa s[70:71], v28, v243 src0_sel:DWORD src1_sel:WORD_1
    v_add_u32_sdwa v219, v243, v130 dst_sel:DWORD dst_unused:UNUSED_PAD src0_sel:WORD_0 src1_sel:DWORD
    v_cmp_lt_u32_sdwa s[72:73], v28, v244 src0_sel:DWORD src1_sel:WORD_1
    v_add_u32_sdwa v220, v244, v130 dst_sel:DWORD dst_unused:UNUSED_PAD src0_sel:WORD_0 src1_sel:DWORD
    v_cmp_lt_u32_sdwa s[74:75], v28, v245 src0_sel:DWORD src1_sel:WORD_1
    v_add_u32_sdwa v221, v245, v130 dst_sel:DWORD dst_unused:UNUSED_PAD src0_sel:WORD_0 src1_sel:DWORD
    v_cmp_lt_u32_sdwa s[76:77], v28, v246 src0_sel:DWORD src1_sel:WORD_1
    v_add_u32_sdwa v222, v246, v130 dst_sel:DWORD dst_unused:UNUSED_PAD src0_sel:WORD_0 src1_sel:DWORD
    v_cmp_lt_u32_sdwa s[78:79], v28, v247 src0_sel:DWORD src1_sel:WORD_1
    v_add_u32_sdwa v223, v247, v130 dst_sel:DWORD dst_unused:UNUSED_PAD src0_sel:WORD_0 src1_sel:DWORD
    v_max3_u32 v60, v240, v241, v242
    v_max3_u32 v60, v60, v243, v244
    v_max3_u32 v60, v60, v245, v246
    v_max_u32 v60, v60, v247
    v_lshrrev_b32 v60, 16, v60
    v_cmp_lt_u32 vcc, v29, v60
    v_cmp_lt_u32 s[60:61], s63, v60
    v_lshl_add_u32 v147, v216, 1, v131
    v_lshl_add_u32 v151, v217, 1, v131
    v_lshl_add_u32 v155, v218, 1, v131
    v_lshl_add_u32 v159, v219, 1, v131
    v_lshl_add_u32 v163, v220, 1, v131
    v_lshl_add_u32 v167, v221, 1, v131
    v_lshl_add_u32 v171, v222, 1, v131
    v_lshl_add_u32 v175, v223, 1, v131
    s_cbranch_vccz K2_nb_end
    s_mov_b32 s54, 0
    v_cmp_lt_u32_sdwa vcc, v29, v247 src0_sel:DWORD src1_sel:WORD_1
    s_cmp_lg_u64 vcc, 0
    s_addc_u32 s54, s54, s54
    v_cmp_lt_u32_sdwa vcc, v29, v246 src0_sel:DWORD src1_sel:WORD_1
    s_cmp_lg_u64 vcc, 0
    s_addc_u32 s54, s54, s54
    v_cmp_lt_u32_sdwa vcc, v29, v245 src0_sel:DWORD src1_sel:WORD_1
    s_cmp_lg_u64 vcc, 0
    s_addc_u32 s54, s54, s54
    v_cmp_lt_u32_sdwa vcc, v29, v244 src0_sel:DWORD src1_sel:WORD_1
    s_cmp_lg_u64 vcc, 0
    s_addc_u32 s54, s54, s54
    v_cmp_lt_u32_sdwa vcc, v29, v243 src0_sel:DWORD src1_sel:WORD_1
    s_cmp_lg_u64 vcc, 0
    s_addc_u32 s54, s54, s54
    v_cmp_lt_u32_sdwa vcc, v29, v242 src0_sel:DWORD src1_sel:WORD_1
    s_cmp_lg_u64 vcc, 0
    s_addc_u32 s54, s54, s54
    v_cmp_lt_u32_sdwa vcc, v29, v241 src0_sel:DWORD src1_sel:WORD_1
    s_cmp_lg_u64 vcc, 0
    s_addc_u32 s54, s54, s54
    v_cmp_lt_u32_sdwa vcc, v29, v240 src0_sel:DWORD src1_sel:WORD_1
    s_cmp_lg_u64 vcc, 0
    s_addc_u32 s54, s54, s54
    s_bcnt1_i32_b32 s62, s54
    s_ff1_i32_b32 s53, s54
    s_bitset0_b32 s54, s53
    s_set_gpr_idx_on s53, gpr_idx(SRC0)
    v_mov_b32 v61, v240
    s_set_gpr_idx_off
    v_add_u32_sdwa v62, v61, v130 dst_sel:DWORD dst_unused:UNUSED_PAD src0_sel:WORD_0 src1_sel:DWORD
    s_mul_i32 s53, s53, 30848
    v_lshl_add_u32 v63, v62, 1, v131
    v_cmp_lt_u32_sdwa s[80:81], v29, v61 src0_sel:DWORD src1_sel:WORD_1
    v_add_u32 v178, s53, v62
    v_add_u32 v179, s53, v63
    s_cmp_eq_u32 s54, 0
    s_cbranch_scc1 K2_nb_end
    s_ff1_i32_b32 s53, s54
    s_bitset0_b32 s54, s53
    s_set_gpr_idx_on s53, gpr_idx(SRC0)
    v_mov_b32 v61, v240
    s_set_gpr_idx_off
    v_add_u32_sdwa v62, v61, v130 dst_sel:DWORD dst_unused:UNUSED_PAD src0_sel:WORD_0 src1_sel:DWORD
    s_mul_i32 s53, s53, 30848
    v_lshl_add_u32 v63, v62, 1, v131
    v_cmp_lt_u32_sdwa s[82:83], v29, v61 src0_sel:DWORD src1_sel:WORD_1
    v_add_u32 v182, s53, v62
    v_add_u32 v183, s53, v63
    s_cmp_eq_u32 s54, 0
    s_cbranch_scc1 K2_nb_end
    s_ff1_i32_b32 s53, s54
    s_bitset0_b32 s54, s53
    s_set_gpr_idx_on s53, gpr_idx(SRC0)
    v_mov_b32 v61, v240
    s_set_gpr_idx_off
    v_add_u32_sdwa v62, v61, v130 dst_sel:DWORD dst_unused:UNUSED_PAD src0_sel:WORD_0 src1_sel:DWORD
    s_mul_i32 s53, s53, 30848
    v_lshl_add_u32 v63, v62, 1, v131
    v_cmp_lt_u32_sdwa s[84:85], v29, v61 src0_sel:DWORD src1_sel:WORD_1
    v_add_u32 v186, s53, v62
    v_add_u32 v187, s53, v63
    s_cmp_eq_u32 s54, 0
    s_cbranch_scc1 K2_nb_end
    s_ff1_i32_b32 s53, s54
    s_bitset0_b32 s54, s53
    s_set_gpr_idx_on s53, gpr_idx(SRC0)
    v_mov_b32 v61, v240
    s_set_gpr_idx_off
    v_add_u32_sdwa v62, v61, v130 dst_sel:DWORD dst_unused:UNUSED_PAD src0_sel:WORD_0 src1_sel:DWORD
    s_mul_i32 s53, s53, 30848
    v_lshl_add_u32 v63, v62, 1, v131
    v_cmp_lt_u32_sdwa s[86:87], v29, v61 src0_sel:DWORD src1_sel:WORD_1
    v_add_u32 v190, s53, v62
    v_add_u32 v191, s53, v63
    s_cmp_eq_u32 s54, 0
    s_cbranch_scc1 K2_nb_end
    s_ff1_i32_b32 s53, s54
    s_bitset0_b32 s54, s53
    s_set_gpr_idx_on s53, gpr_idx(SRC0)
    v_mov_b32 v61, v240
    s_set_gpr_idx_off
    v_add_u32_sdwa v62, v61, v130 dst_sel:DWORD dst_unused:UNUSED_PAD src0_sel:WORD_0 src1_sel:DWORD
    s_mul_i32 s53, s53, 30848
    v_lshl_add_u32 v63, v62, 1, v131
    v_cmp_lt_u32_sdwa s[88:89], v29, v61 src0_sel:DWORD src1_sel:WORD_1
    v_add_u32 v194, s53, v62
    v_add_u32 v195, s53, v63
    s_cmp_eq_u32 s54, 0
    s_cbranch_scc1 K2_nb_end
    s_ff1_i32_b32 s53, s54
    s_bitset0_b32 s54, s53
    s_set_gpr_idx_on s53, gpr_idx(SRC0)
    v_mov_b32 v61, v240
    s_set_gpr_idx_off
    v_add_u32_sdwa v62, v61, v130 dst_sel:DWORD dst_unused:UNUSED_PAD src0_sel:WORD_0 src1_sel:DWORD
    s_mul_i32 s53, s53, 30848
    v_lshl_add_u32 v63, v62, 1, v131
    v_cmp_lt_u32_sdwa s[90:91], v29, v61 src0_sel:DWORD src1_sel:WORD_1
    v_add_u32 v198, s53, v62
    v_add_u32 v199, s53, v63
    s_cmp_eq_u32 s54, 0
    s_cbranch_scc1 K2_nb_end
    s_ff1_i32_b32 s53, s54
    s_bitset0_b32 s54, s53
    s_set_gpr_idx_on s53, gpr_idx(SRC0)
    v_mov_b32 v61, v240
    s_set_gpr_idx_off
    v_add_u32_sdwa v62, v61, v130 dst_sel:DWORD dst_unused:UNUSED_PAD src0_sel:WORD_0 src1_sel:DWORD
    s_mul_i32 s53, s53, 30848
    v_lshl_add_u32 v63, v62, 1, v131
    v_cmp_lt_u32_sdwa s[92:93], v29, v61 src0_sel:DWORD src1_sel:WORD_1
    v_add_u32 v202, s53, v62
    v_add_u32 v203, s53, v63
    s_cmp_eq_u32 s54, 0
    s_cbranch_scc1 K2_nb_end
    s_ff1_i32_b32 s53, s54
    s_bitset0_b32 s54, s53
    s_set_gpr_idx_on s53, gpr_idx(SRC0)
    v_mov_b32 v61, v240
    s_set_gpr_idx_off
    v_add_u32_sdwa v62, v61, v130 dst_sel:DWORD dst_unused:UNUSED_PAD src0_sel:WORD_0 src1_sel:DWORD
    s_mul_i32 s53, s53, 30848
    v_lshl_add_u32 v63, v62, 1, v131
    v_cmp_lt_u32_sdwa s[94:95], v29, v61 src0_sel:DWORD src1_sel:WORD_1
    v_add_u32 v206, s53, v62
    v_add_u32 v207, s53, v63
    s_cmp_eq_u32 s54, 0
K2_nb_end:
    s_cmp_eq_u32 s38, 0
    s_cbranch_scc1 K2_ready
    s_and_b32 s3, s44, 3
    s_lshl_b32 s3, s3, 5
    v_bfe_u32 v62, v0, 4, 2
    v_lshl_add_u32 v62, v62, 3, s3
    global_load_dwordx2 v[128:129], v62, s[12:13]
    s_mov_b32 m0, s52
    s_lshl_b32 s3, s44, 11
    buffer_load_dwordx4 v7, s[28:31], s3 offen offset:0 lds
    buffer_load_dwordx4 v7, s[28:31], s3 offen offset:1024 lds
    s_cmp_lg_u32 s44, 7
    s_cbranch_scc1 K2_polled
    s_mov_b32 s43, 0
    s_mov_b64 s[48:49], -1
    s_mov_b64 s[50:51], -1
K2_poll:
    s_mov_b64 exec, s[48:49]
    buffer_load_dwordx4 v[68:71], v7, s[36:39], 0 offen offset:1024 sc1
    s_mov_b64 exec, s[50:51]
    buffer_load_dwordx4 v[72:75], v7, s[36:39], 0 offen offset:2048 sc1
    s_mov_b64 exec, -1
    s_add_u32 s43, s43, 1
    s_cmp_gt_u32 s43, 1048576
    s_cbranch_scc1 K2_pdone
    s_waitcnt vmcnt(0)
    v_cmp_ne_u64 s[48:49], s[40:41], v[68:69]
    v_cmp_ne_u64 vcc, s[40:41], v[70:71]
    s_or_b64 s[48:49], s[48:49], vcc
    v_cmp_ne_u64 s[50:51], s[40:41], v[72:73]
    v_cmp_ne_u64 vcc, s[40:41], v[74:75]
    s_or_b64 s[50:51], s[50:51], vcc
    s_or_b64 vcc, s[48:49], s[50:51]
    s_cbranch_scc0 K2_pdone
    s_branch K2_poll
K2_pdone:
    s_mov_b32 s48, 0
K2_polled:
    s_waitcnt vmcnt(0)
    s_barrier
K2_ready:
    s_cmp_le_u32 s62, 0
    s_cbranch_scc1 K2_nl_end
    s_mov_b64 exec, s[80:81]
    buffer_load_dwordx2 v[176:177], v179, s[20:23], 0 offen offset:128 sc1
    buffer_load_dword v178, v178, s[20:23], 0 offen offset:64 sc1
    s_cmp_le_u32 s62, 1
    s_cbranch_scc1 K2_nl_end
    s_mov_b64 exec, s[82:83]
    buffer_load_dwordx2 v[180:181], v183, s[20:23], 0 offen offset:128 sc1
    buffer_load_dword v182, v182, s[20:23], 0 offen offset:64 sc1
    s_cmp_le_u32 s62, 2
    s_cbranch_scc1 K2_nl_end
    s_mov_b64 exec, s[84:85]
    buffer_load_dwordx2 v[184:185], v187, s[20:23], 0 offen offset:128 sc1
    buffer_load_dword v186, v186, s[20:23], 0 offen offset:64 sc1
    s_cmp_le_u32 s62, 3
    s_cbranch_scc1 K2_nl_end
    s_mov_b64 exec, s[86:87]
    buffer_load_dwordx2 v[188:189], v191, s[20:23], 0 offen offset:128 sc1
    buffer_load_dword v190, v190, s[20:23], 0 offen offset:64 sc1
    s_cmp_le_u32 s62, 4
    s_cbranch_scc1 K2_nl_end
    s_mov_b64 exec, s[88:89]
    buffer_load_dwordx2 v[192:193], v195, s[20:23], 0 offen offset:128 sc1
    buffer_load_dword v194, v194, s[20:23], 0 offen offset:64 sc1
    s_cmp_le_u32 s62, 5
    s_cbranch_scc1 K2_nl_end
    s_mov_b64 exec, s[90:91]
    buffer_load_dwordx2 v[196:197], v199, s[20:23], 0 offen offset:128 sc1
    buffer_load_dword v198, v198, s[20:23], 0 offen offset:64 sc1
    s_cmp_le_u32 s62, 6
    s_cbranch_scc1 K2_nl_end
    s_mov_b64 exec, s[92:93]
    buffer_load_dwordx2 v[200:201], v203, s[20:23], 0 offen offset:128 sc1
    buffer_load_dword v202, v202, s[20:23], 0 offen offset:64 sc1
    s_cmp_le_u32 s62, 7
    s_cbranch_scc1 K2_nl_end
    s_mov_b64 exec, s[94:95]
    buffer_load_dwordx2 v[204:205], v207, s[20:23], 0 offen offset:128 sc1
    buffer_load_dword v206, v206, s[20:23], 0 offen offset:64 sc1
K2_nl_end:
    s_mov_b64 exec, -1
    s_mov_b64 exec, s[64:65]
    buffer_load_dword v146, v216, s[20:23], s4 offen sc1
    s_mov_b64 exec, s[66:67]
    buffer_load_dword v150, v217, s[20:23], s5 offen sc1
    s_mov_b64 exec, s[68:69]
    buffer_load_dword v154, v218, s[20:23], s6 offen sc1
    s_mov_b64 exec, s[70:71]
    buffer_load_dword v158, v219, s[20:23], s7 offen sc1
    s_mov_b64 exec, s[72:73]
    buffer_load_dword v162, v220, s[20:23], s8 offen sc1
    s_mov_b64 exec, s[74:75]
    buffer_load_dword v166, v221, s[20:23], s9 offen sc1
    s_mov_b64 exec, s[76:77]
    buffer_load_dword v170, v222, s[20:23], s10 offen sc1
    s_mov_b64 exec, s[78:79]
    buffer_load_dword v174, v223, s[20:23], s11 offen sc1
    s_mov_b64 exec, -1
    s_waitcnt lgkmcnt(0)
    s_barrier
K2_nob0:
    s_mov_b64 exec, s[64:65]
    buffer_load_dwordx2 v[144:145], v147, s[20:23], s4 offen sc1
    s_mov_b64 exec, s[66:67]
    buffer_load_dwordx2 v[148:149], v151, s[20:23], s5 offen sc1
    s_mov_b64 exec, -1
    s_cmp_eq_u32 s38, 0
    s_cbranch_scc1 K2_now2
    ds_read_b64_tr_b16 v[112:113], v13 offset:0
    ds_read_b64_tr_b16 v[114:115], v13 offset:512
    ds_read_b64_tr_b16 v[116:117], v13 offset:16384
    ds_read_b64_tr_b16 v[118:119], v13 offset:16896
    ds_read_b64_tr_b16 v[120:121], v13 offset:32768
    ds_read_b64_tr_b16 v[122:123], v13 offset:33280
    ds_read_b64_tr_b16 v[124:125], v13 offset:49152
    ds_read_b64_tr_b16 v[126:127], v13 offset:49664
K2_now2:
    s_mov_b32 s38, 0
    s_cmp_eq_u64 s[60:61], 0
    s_cbranch_scc1 K2_nomax
    ds_max_u32 v56, v60 offset:48128
K2_nomax:
    v_mov_b32 v64, 0
    v_mov_b32 v65, 0
    v_mov_b32 v67, 0
    v_mov_b32 v66, 0xffff
    v_lshl_or_b32 v66, v101, 16, v66
    v_cmp_eq_u32 vcc, 63, v1
    v_mov_b32 v62, 113920
    v_mov_b32 v63, 0x28000
    v_mov_b32 v8, 16
    v_cndmask_b32 v62, v62, v63, vcc
    s_waitcnt vmcnt(8)
    s_mov_b64 exec, s[64:65]
    v_lshrrev_b32 v224, 16, v146
    ds_add_rtn_u32 v208, v224, v8 offset:47360
    s_mov_b64 exec, s[66:67]
    v_lshrrev_b32 v225, 16, v150
    ds_add_rtn_u32 v209, v225, v8 offset:47360
    s_waitcnt vmcnt(6)
    s_mov_b64 exec, s[68:69]
    v_lshrrev_b32 v226, 16, v154
    ds_add_rtn_u32 v210, v226, v8 offset:47360
    s_mov_b64 exec, s[70:71]
    v_lshrrev_b32 v227, 16, v158
    ds_add_rtn_u32 v211, v227, v8 offset:47360
    s_waitcnt vmcnt(4)
    s_mov_b64 exec, s[72:73]
    v_lshrrev_b32 v228, 16, v162
    ds_add_rtn_u32 v212, v228, v8 offset:47360
    s_mov_b64 exec, s[74:75]
    v_lshrrev_b32 v229, 16, v166
    ds_add_rtn_u32 v213, v229, v8 offset:47360
    s_waitcnt vmcnt(2)
    s_mov_b64 exec, s[76:77]
    v_lshrrev_b32 v230, 16, v170
    ds_add_rtn_u32 v214, v230, v8 offset:47360
    s_mov_b64 exec, s[78:79]
    v_lshrrev_b32 v231, 16, v174
    ds_add_rtn_u32 v215, v231, v8 offset:47360
    s_mov_b64 exec, s[68:69]
    buffer_load_dwordx2 v[152:153], v155, s[20:23], s6 offen sc1
    s_mov_b64 exec, s[70:71]
    buffer_load_dwordx2 v[156:157], v159, s[20:23], s7 offen sc1
    s_mov_b64 exec, s[72:73]
    buffer_load_dwordx2 v[160:161], v163, s[20:23], s8 offen sc1
    s_mov_b64 exec, -1
    s_cmp_le_u32 s62, 0
    s_cbranch_scc1 K2_nh_end
    s_mov_b64 exec, s[80:81]
    v_lshrrev_b32 v232, 16, v178
    ds_add_rtn_u32 v216, v232, v8 offset:47360
    s_cmp_le_u32 s62, 1
    s_cbranch_scc1 K2_nh_end
    s_mov_b64 exec, s[82:83]
    v_lshrrev_b32 v233, 16, v182
    ds_add_rtn_u32 v217, v233, v8 offset:47360
    s_cmp_le_u32 s62, 2
    s_cbranch_scc1 K2_nh_end
    s_mov_b64 exec, s[84:85]
    v_lshrrev_b32 v234, 16, v186
    ds_add_rtn_u32 v218, v234, v8 offset:47360
    s_cmp_le_u32 s62, 3
    s_cbranch_scc1 K2_nh_end
    s_mov_b64 exec, s[86:87]
    v_lshrrev_b32 v235, 16, v190
    ds_add_rtn_u32 v219, v235, v8 offset:47360
    s_cmp_le_u32 s62, 4
    s_cbranch_scc1 K2_nh_end
    s_mov_b64 exec, s[88:89]
    v_lshrrev_b32 v236, 16, v194
    ds_add_rtn_u32 v220, v236, v8 offset:47360
    s_cmp_le_u32 s62, 5
    s_cbranch_scc1 K2_nh_end
    s_mov_b64 exec, s[90:91]
    v_lshrrev_b32 v237, 16, v198
    ds_add_rtn_u32 v221, v237, v8 offset:47360
    s_cmp_le_u32 s62, 6
    s_cbranch_scc1 K2_nh_end
    s_mov_b64 exec, s[92:93]
    v_lshrrev_b32 v238, 16, v202
    ds_add_rtn_u32 v222, v238, v8 offset:47360
    s_cmp_le_u32 s62, 7
    s_cbranch_scc1 K2_nh_end
    s_mov_b64 exec, s[94:95]
    v_lshrrev_b32 v239, 16, v206
    ds_add_rtn_u32 v223, v239, v8 offset:47360
K2_nh_end:
    s_mov_b64 exec, -1
    s_lshl_b32 s53, s44, 4
    s_waitcnt lgkmcnt(0)
    s_barrier
    ds_read_b32 v98, v101 offset:47360
    ds_read_b32 v10, v56 offset:48128
    s_mov_b64 exec, s[74:75]
    buffer_load_dwordx2 v[164:165], v167, s[20:23], s9 offen sc1
    s_mov_b64 exec, s[76:77]
    buffer_load_dwordx2 v[168:169], v171, s[20:23], s10 offen sc1
    s_mov_b64 exec, s[78:79]
    buffer_load_dwordx2 v[172:173], v175, s[20:23], s11 offen sc1
    s_mov_b64 exec, -1
    s_waitcnt lgkmcnt(0)
    v_add_u32 v99, 112, v98
    v_and_b32 v99, 0xffffff80, v99
    v_mov_b32 v100, v99
    s_nop 1
    v_add_u32_dpp v100, v100, v100 row_shr:1 row_mask:0xf bank_mask:0xf bound_ctrl:0
    s_nop 1
    v_add_u32_dpp v100, v100, v100 row_shr:2 row_mask:0xf bank_mask:0xf bound_ctrl:0
    s_nop 1
    v_add_u32_dpp v100, v100, v100 row_shr:4 row_mask:0xf bank_mask:0xf bound_ctrl:0
    s_nop 1
    v_add_u32_dpp v100, v100, v100 row_shr:8 row_mask:0xf bank_mask:0xf bound_ctrl:0
    s_nop 1
    v_add_u32_dpp v100, v100, v100 row_bcast:15 row_mask:0xa bank_mask:0xf
    s_nop 1
    v_add_u32_dpp v100, v100, v100 row_bcast:31 row_mask:0xc bank_mask:0xf
    v_add_u32 v61, s53, v98
    v_readlane_b32 s50, v100, 63
    v_sub_u32 v100, v100, v99
    v_add_u32 v60, v62, v100
    ds_write_b32 v101, v60 offset:47616
    v_cmp_lt_u32 vcc, v61, v99
    v_add_u32 v61, v61, v60
    ds_read_b32 v224, v224 offset:47616
    ds_read_b32 v225, v225 offset:47616
    ds_read_b32 v226, v226 offset:47616
    ds_read_b32 v227, v227 offset:47616
    ds_read_b32 v228, v228 offset:47616
    ds_read_b32 v229, v229 offset:47616
    ds_read_b32 v230, v230 offset:47616
    ds_read_b32 v231, v231 offset:47616
    s_cmp_le_u32 s62, 0
    s_cbranch_scc1 K2_nr_end
    s_mov_b64 exec, s[80:81]
    ds_read_b32 v232, v232 offset:47616
    s_cmp_le_u32 s62, 1
    s_cbranch_scc1 K2_nr_end
    s_mov_b64 exec, s[82:83]
    ds_read_b32 v233, v233 offset:47616
    s_cmp_le_u32 s62, 2
    s_cbranch_scc1 K2_nr_end
    s_mov_b64 exec, s[84:85]
    ds_read_b32 v234, v234 offset:47616
    s_cmp_le_u32 s62, 3
    s_cbranch_scc1 K2_nr_end
    s_mov_b64 exec, s[86:87]
    ds_read_b32 v235, v235 offset:47616
    s_cmp_le_u32 s62, 4
    s_cbranch_scc1 K2_nr_end
    s_mov_b64 exec, s[88:89]
    ds_read_b32 v236, v236 offset:47616
    s_cmp_le_u32 s62, 5
    s_cbranch_scc1 K2_nr_end
    s_mov_b64 exec, s[90:91]
    ds_read_b32 v237, v237 offset:47616
    s_cmp_le_u32 s62, 6
    s_cbranch_scc1 K2_nr_end
    s_mov_b64 exec, s[92:93]
    ds_read_b32 v238, v238 offset:47616
    s_cmp_le_u32 s62, 7
    s_cbranch_scc1 K2_nr_end
    s_mov_b64 exec, s[94:95]
    ds_read_b32 v239, v239 offset:47616
K2_nr_end:
    s_mov_b64 exec, -1
    v_readfirstlane_b32 s49, v10
    s_cmp_lg_u32 s46, 32
    s_cbranch_scc1 K2_fits
    s_cmp_gt_u32 s50, 47104
    s_cbranch_scc1 K2_nofit
    s_cmp_gt_u32 s49, 128
    s_cbranch_scc1 K2_nofit
K2_fits:
    s_mov_b32 s47, 0
    s_mov_b64 exec, vcc
    s_cmp_lg_u32 s44, 7
    s_cbranch_scc1 K2_padw
    s_mov_b64 exec, -1
    ds_add_u32 v101, v98 offset:47872
    s_add_u32 s53, s50, 113920
    v_add_u32 v61, s53, v7
    v_mov_b32 v66, 0xa0ffff
    ds_write_b128 v61, v[64:67] offset:1024
K2_padw:
    ds_write_b128 v61, v[64:67]
    s_mov_b64 exec, -1
    s_waitcnt lgkmcnt(1)
    v_add_u32 v224, v224, v208
    v_add_u32 v225, v225, v209
    v_add_u32 v226, v226, v210
    v_add_u32 v227, v227, v211
    v_add_u32 v228, v228, v212
    v_add_u32 v229, v229, v213
    v_add_u32 v230, v230, v214
    v_add_u32 v231, v231, v215
    s_waitcnt vmcnt(6)
    ds_write_b96 v224, v[144:146]
    ds_write_b96 v225, v[148:150]
    s_waitcnt vmcnt(4)
    ds_write_b96 v226, v[152:154]
    ds_write_b96 v227, v[156:158]
    s_waitcnt vmcnt(2)
    ds_write_b96 v228, v[160:162]
    ds_write_b96 v229, v[164:166]
    s_waitcnt vmcnt(0)
    ds_write_b96 v230, v[168:170]
    ds_write_b96 v231, v[172:174]
    s_cmp_le_u32 s62, 0
    s_cbranch_scc1 K2_ns_end
    s_mov_b64 exec, s[80:81]
    v_add_u32 v232, v232, v216
    ds_write_b96 v232, v[176:178]
    s_cmp_le_u32 s62, 1
    s_cbranch_scc1 K2_ns_end
    s_mov_b64 exec, s[82:83]
    v_add_u32 v233, v233, v217
    ds_write_b96 v233, v[180:182]
    s_cmp_le_u32 s62, 2
    s_cbranch_scc1 K2_ns_end
    s_mov_b64 exec, s[84:85]
    v_add_u32 v234, v234, v218
    ds_write_b96 v234, v[184:186]
    s_cmp_le_u32 s62, 3
    s_cbranch_scc1 K2_ns_end
    s_mov_b64 exec, s[86:87]
    v_add_u32 v235, v235, v219
    ds_write_b96 v235, v[188:190]
    s_cmp_le_u32 s62, 4
    s_cbranch_scc1 K2_ns_end
    s_mov_b64 exec, s[88:89]
    v_add_u32 v236, v236, v220
    ds_write_b96 v236, v[192:194]
    s_cmp_le_u32 s62, 5
    s_cbranch_scc1 K2_ns_end
    s_mov_b64 exec, s[90:91]
    v_add_u32 v237, v237, v221
    ds_write_b96 v237, v[196:198]
    s_cmp_le_u32 s62, 6
    s_cbranch_scc1 K2_ns_end
    s_mov_b64 exec, s[92:93]
    v_add_u32 v238, v238, v222
    ds_write_b96 v238, v[200:202]
    s_cmp_le_u32 s62, 7
    s_cbranch_scc1 K2_ns_end
    s_mov_b64 exec, s[94:95]
    v_add_u32 v239, v239, v223
    ds_write_b96 v239, v[204:206]
K2_ns_end:
    s_mov_b64 exec, -1
    s_add_u32 s50, s50, 2047
    s_lshr_b32 s50, s50, 11
    s_mul_i32 s61, s50, 27
    s_add_u32 s61, s61, 32
    s_lshr_b32 s61, s61, 6
    s_sub_u32 s60, s50, s61
    s_and_b32 s53, s44, 3
    s_lshl_b32 s54, s60, 11
    s_cmp_ge_u32 s44, 4
    s_cselect_b32 s50, s61, s60
    s_cselect_b32 s54, s54, 0
    s_mul_i32 s53, s53, s50
    s_lshl_b32 s53, s53, 9
    s_add_u32 s53, s53, s54
    s_add_u32 s53, s53, 113920
    s_lshl_b32 s54, s50, 7
    v_mad_u32_u24 v3, v248, s54, v142
    v_mad_u32_u24 v4, v249, s54, v143
    v_mad_u32_u24 v5, v250, s54, 10
    v_add_u32 v3, s53, v3
    v_add_u32 v4, s53, v4
    v_add_u32 v5, s53, v5
    v_add_u32 v6, s54, v5
    s_mov_b32 s51, 0
    s_mov_b32 m0, s52
    s_waitcnt lgkmcnt(0)
    s_barrier
    ds_read_u16 v16, v4 offset:0
    ds_read_u16 v18, v4 offset:32
    ds_read_u16 v20, v4 offset:64
    ds_read_u16 v22, v4 offset:96
    ds_read_u16 v96, v5 offset:0
    ds_read_u16 v97, v6 offset:0
    s_waitcnt lgkmcnt(2)
    s_cmp_ge_u32 s44, 4
    s_cbranch_scc1 K2_fda
    buffer_load_dwordx4 v[16:17], s[16:19], 0 idxen offen offset:0 sc1 lds
    buffer_load_dwordx4 v[18:19], s[16:19], 0 idxen offen offset:1024 sc1 lds
    buffer_load_dwordx4 v[20:21], s[16:19], 0 idxen offen offset:2048 sc1 lds
    buffer_load_dwordx4 v[22:23], s[16:19], 0 idxen offen offset:3072 sc1 lds
    s_mov_b32 m0, s14
    s_nop 0
    buffer_load_dwordx4 v[16:17], s[16:19], s15 idxen offen offset:0 sc1 lds
    buffer_load_dwordx4 v[18:19], s[16:19], s15 idxen offen offset:1024 sc1 lds
    buffer_load_dwordx4 v[20:21], s[16:19], s15 idxen offen offset:2048 sc1 lds
    buffer_load_dwordx4 v[22:23], s[16:19], s15 idxen offen offset:3072 sc1 lds
K2_fda:
    ds_read_b64 v[88:89], v3 offset:0
    s_mov_b64 exec, s[56:57]
    ds_read_b32 v90, v3 offset:12
    s_mov_b64 exec, s[58:59]
    ds_read_b32 v91, v3 offset:12
    s_mov_b64 exec, -1
    ds_read_b64 v[92:93], v3 offset:128
    s_mov_b64 exec, s[56:57]
    ds_read_b32 v94, v3 offset:140
    s_mov_b64 exec, s[58:59]
    ds_read_b32 v95, v3 offset:140
    s_mov_b64 exec, -1
    s_waitcnt lgkmcnt(6)
    v_lshl_add_u32 v24, v96, 6, v251
    v_lshl_add_u32 v25, v97, 6, v251
    v_lshl_add_u32 v26, v24, 1, v11
    v_lshl_add_u32 v27, v25, 1, v11
    ds_read_u16_d16_hi v42, v24 offset:0
    ds_read_u16_d16_hi v43, v25 offset:0
    ds_read_u16_d16_hi v46, v24 offset:64
    ds_read_u16_d16_hi v47, v25 offset:64
    ds_read_u16_d16_hi v50, v24 offset:128
    ds_read_u16_d16_hi v51, v25 offset:128
    ds_read_u16_d16_hi v54, v24 offset:192
    ds_read_u16_d16_hi v55, v25 offset:192
    ds_read_u16 v14, v5 offset:128
    ds_read_u16 v15, v6 offset:128
    v_mov_b32 v192, 0
    v_mov_b32 v193, 0
    v_mov_b32 v32, 0
    v_mov_b32 v33, 0
    v_mov_b32 v200, 0
    v_mov_b32 v201, 0
    v_mov_b32 v202, 0
    v_mov_b32 v203, 0
    v_mov_b32 v204, 0
    v_mov_b32 v205, 0
    v_mov_b32 v206, 0
    v_mov_b32 v207, 0
    s_mov_b64 s[78:79], 0
    v_mov_b32 v194, 1.0
    v_mov_b32 v195, 1.0
    v_mov_b32 v196, 1.0
    v_mov_b32 v197, 1.0
    v_mov_b32 v34, 1.0
    v_mov_b32 v35, 1.0
    v_mov_b32 v36, 1.0
    v_mov_b32 v37, 1.0
    s_max_u32 s53, s61, 1
    v_cvt_f32_u32 v160, s60
    v_cvt_f32_u32 v161, s53
    v_add_u32 v162, 64, v100
    v_add_u32 v163, v100, v99
    v_subrev_u32 v163, 64, v163
    v_mul_f32 v166, 0xc1800000, v160
    v_rcp_f32 v160, v160
    v_rcp_f32 v161, v161
    v_cvt_f32_i32 v162, v162
    v_cvt_f32_i32 v163, v163
    v_mov_b32 v167, 0x41800000
    v_fma_f32 v166, v166, v161, v167
    v_mul_f32 v160, 0x3c000000, v160
    v_mul_f32 v161, 0x3c000000, v161
    v_fma_f32 v164, v162, v161, v166
    v_mul_f32 v162, v162, v160
    v_max_f32 v162, v162, v164
    v_cvt_u32_f32 v162, v162
    v_fma_f32 v164, v163, v161, v166
    v_mul_f32 v163, v163, v160
    v_max_f32 v163, v163, v164
    v_cvt_u32_f32 v163, v163
    v_cmp_ne_u32 vcc, 0, v99
    v_sub_u32 v163, v163, v162
    v_add_lshl_u32 v162, v162, v1, 1
    v_mov_b32 v167, 142
    v_cndmask_b32 v163, -1, v163, vcc
    v_cndmask_b32 v164, v167, v162, vcc
    v_cmp_le_i32 vcc, 1, v163
    v_cmp_le_i32 s[64:65], 2, v163
    v_add_u32 v165, 2, v162
    v_add_u32 v166, 4, v162
    v_add_u32 v163, 1, v163
    v_cndmask_b32 v165, v167, v165, vcc
    v_cndmask_b32 v166, v167, v166, s[64:65]
    v_lshl_or_b32 v164, v165, 8, v164
    v_lshl_or_b32 v166, v163, 8, v166
    v_lshl_or_b32 v139, v166, 16, v164
    v_lshrrev_b32 v208, 5, v0
    v_lshlrev_b32 v10, 2, v208
    s_lshr_b32 s54, s44, 2
    v_and_b32 v8, 15, v0
    s_lshl_b32 s53, s54, 6
    v_lshl_add_u32 v160, v8, 2, s53
    ds_bpermute_b32 v141, v10, v139 offset:128
    ds_bpermute_b32 v140, v10, v139 offset:64
    ds_bpermute_b32 v139, v10, v139 offset:0
    ds_read_b32 v214, v160 offset:47872
    ds_read_b32 v215, v160 offset:48000
    v_mul_u32_u24 v208, 272, v208
    v_lshl_add_u32 v208, v2, 1, v208
    v_add_u32 v208, 113920, v208
    v_bfe_u32 v9, v0, 4, 2
    v_mul_u32_u24 v209, 272, v8
    v_lshl_add_u32 v209, v9, 4, v209
    s_mul_i32 s53, s54, 4352
    s_add_u32 s53, s53, 113920
    v_add_u32 v209, s53, v209
    v_lshlrev_b32 v210, 7, v8
    v_lshl_add_u32 v210, v9, 3, v210
    s_lshl_b32 s53, s54, 4
    v_add_u32 v8, s53, v8
    v_cmp_gt_u32 s[68:69], s97, v8
    v_add_u32 v8, 32, v8
    v_cmp_gt_u32 s[70:71], s97, v8
    v_bfe_u32 v161, v0, 4, 1
    v_mul_u32_u24 v161, 0x10101, v161
    v_lshlrev_b32 v162, 2, v2
    v_mov_b32 v212, 0
    s_mov_b32 s4, 0xc0c0400
    s_mov_b32 s5, 0xc0c0500
    s_mov_b32 s6, 0xc0c0600
    s_add_u32 s53, s53, s55
    s_lshl_b32 s53, s53, 7
    s_and_b32 s54, s44, 3
    s_lshl_b32 s54, s54, 5
    s_add_u32 s7, s53, s54
    s_add_u32 s8, s7, 4096
    s_mov_b32 s10, 0x7b800000
    s_mov_b32 s96, 0xbf317218
    s_waitcnt lgkmcnt(0)
    v_add_u32 v139, v139, v161
    v_perm_b32 v130, v139, v162, s4
    v_perm_b32 v131, v139, v162, s5
    v_perm_b32 v132, v139, v162, s6
    v_lshrrev_b32 v139, 24, v139
    v_add_u32 v140, v140, v161
    v_perm_b32 v133, v140, v162, s4
    v_perm_b32 v134, v140, v162, s5
    v_perm_b32 v135, v140, v162, s6
    v_lshrrev_b32 v140, 24, v140
    v_add_u32 v141, v141, v161
    v_perm_b32 v136, v141, v162, s4
    v_perm_b32 v137, v141, v162, s5
    v_perm_b32 v138, v141, v162, s6
    v_lshrrev_b32 v141, 24, v141
    v_max3_u32 v211, v139, v140, v141
    v_cmp_lt_u32 s[72:73], 3, v211
    v_lshrrev_b32 v214, 4, v214
    v_cvt_f32_u32 v214, v214
    v_lshrrev_b32 v215, 4, v215
    v_cvt_f32_u32 v215, v215
    s_cmp_lt_u32 s44, 4
    s_cbranch_scc1 K2_fdb
    buffer_load_dwordx4 v[16:17], s[16:19], 0 idxen offen offset:0 sc1 lds
    buffer_load_dwordx4 v[18:19], s[16:19], 0 idxen offen offset:1024 sc1 lds
    buffer_load_dwordx4 v[20:21], s[16:19], 0 idxen offen offset:2048 sc1 lds
    buffer_load_dwordx4 v[22:23], s[16:19], 0 idxen offen offset:3072 sc1 lds
    s_mov_b32 m0, s14
    s_nop 0
    buffer_load_dwordx4 v[16:17], s[16:19], s15 idxen offen offset:0 sc1 lds
    buffer_load_dwordx4 v[18:19], s[16:19], s15 idxen offen offset:1024 sc1 lds
    buffer_load_dwordx4 v[20:21], s[16:19], s15 idxen offen offset:2048 sc1 lds
    buffer_load_dwordx4 v[22:23], s[16:19], s15 idxen offen offset:3072 sc1 lds
K2_fdb:
    ds_read_u16 v16, v4 offset:128
    ds_read_u16 v18, v4 offset:160
    ds_read_u16 v20, v4 offset:192
    ds_read_u16 v22, v4 offset:224
    s_waitcnt vmcnt(4)
    s_cmp_eq_u32 s50, 0
    s_cbranch_scc1 K2_idle
    ds_read_b64_tr_b16 v[56:57], v12 offset:0
    ds_read_b64_tr_b16 v[58:59], v12 offset:256
    ds_read_b64_tr_b16 v[60:61], v12 offset:1024
    ds_read_b64_tr_b16 v[62:63], v12 offset:1280
    ds_read_b64_tr_b16 v[64:65], v12 offset:2048
    ds_read_b64_tr_b16 v[66:67], v12 offset:2304
    ds_read_b64_tr_b16 v[68:69], v12 offset:3072
    ds_read_b64_tr_b16 v[70:71], v12 offset:3328
    ds_read_b64_tr_b16 v[72:73], v12 offset:64
    ds_read_b64_tr_b16 v[74:75], v12 offset:320
    ds_read_b64_tr_b16 v[76:77], v12 offset:1088
    ds_read_b64_tr_b16 v[78:79], v12 offset:1344
    ds_read_b64_tr_b16 v[80:81], v12 offset:2112
    ds_read_b64_tr_b16 v[82:83], v12 offset:2368
    ds_read_b64_tr_b16 v[84:85], v12 offset:3136
    ds_read_b64_tr_b16 v[86:87], v12 offset:3392
    s_mov_b32 m0, s52
    s_waitcnt lgkmcnt(0)
    buffer_load_dwordx4 v[16:17], s[16:19], 0 idxen offen offset:0 sc1 lds
    buffer_load_dwordx4 v[18:19], s[16:19], 0 idxen offen offset:1024 sc1 lds
    buffer_load_dwordx4 v[20:21], s[16:19], 0 idxen offen offset:2048 sc1 lds
    buffer_load_dwordx4 v[22:23], s[16:19], 0 idxen offen offset:3072 sc1 lds
    v_mfma_f32_32x32x16_bf16 v[144:159], v[88:91], v[40:43], v[56:71]
    s_waitcnt vmcnt(4)
    ds_read_b64_tr_b16 v[216:217], v12 offset:4096
    ds_read_b64_tr_b16 v[218:219], v12 offset:4352
    ds_read_b64_tr_b16 v[220:221], v12 offset:5120
    ds_read_b64_tr_b16 v[222:223], v12 offset:5376
    ds_read_b64_tr_b16 v[224:225], v12 offset:6144
    ds_read_b64_tr_b16 v[226:227], v12 offset:6400
    ds_read_b64_tr_b16 v[228:229], v12 offset:7168
    ds_read_b64_tr_b16 v[230:231], v12 offset:7424
    ds_read_b64_tr_b16 v[232:233], v12 offset:4160
    ds_read_b64_tr_b16 v[234:235], v12 offset:4416
    ds_read_b64_tr_b16 v[236:237], v12 offset:5184
    ds_read_b64_tr_b16 v[238:239], v12 offset:5440
    ds_read_b64_tr_b16 v[240:241], v12 offset:6208
    ds_read_b64_tr_b16 v[242:243], v12 offset:6464
    ds_read_b64_tr_b16 v[244:245], v12 offset:7232
    ds_read_b64_tr_b16 v[246:247], v12 offset:7488
    s_mov_b32 m0, s14
    s_setprio 0
    s_cmp_lg_u32 s48, 0
    s_cbranch_scc1 K2_loopS
    .p2align 6
K2_loopF:
    v_rcp_f32 v198, v36
    v_rcp_f32 v199, v37
    s_setprio 1
    v_exp_f32 v176, v144
    v_exp_f32 v177, v145
    v_exp_f32 v178, v146
    v_exp_f32 v179, v147
    v_exp_f32 v180, v148
    v_exp_f32_e64 v181, v149
    v_mfma_f32_32x32x16_bf16 v[160:175], v[88:91], v[44:47], v[72:87]
    v_exp_f32 v182, v150
    v_exp_f32 v183, v151
    v_exp_f32 v184, v152
    v_exp_f32 v185, v153
    v_exp_f32 v186, v154
    v_exp_f32 v187, v155
    v_exp_f32 v188, v156
    v_exp_f32 v189, v157
    v_exp_f32 v190, v158
    v_exp_f32_e64 v191, v159
    s_cmp_lg_u64 s[78:79], 0
    v_pk_mul_f32 v[192:193], v[192:193], v[196:197]
    v_pk_mul_f32 v[32:33], v[32:33], v[194:195]
    v_pk_fma_f32 v[204:205], v[192:193], v[198:199], v[204:205]
    v_pk_fma_f32 v[206:207], v[32:33], v[198:199], v[206:207]
    v_pk_fma_f32 v[30:31], v[34:35], v[36:37], v[30:31]
    s_waitcnt lgkmcnt(0)
    s_cbranch_scc1 K2_flF0
K2_flrF0:
    buffer_load_dwordx4 v[16:17], s[16:19], s15 idxen offen offset:0 sc1 lds
    buffer_load_dwordx4 v[18:19], s[16:19], s15 idxen offen offset:1024 sc1 lds
    buffer_load_dwordx4 v[20:21], s[16:19], s15 idxen offen offset:2048 sc1 lds
    buffer_load_dwordx4 v[22:23], s[16:19], s15 idxen offen offset:3072 sc1 lds
    s_setprio 0
    s_mov_b32 m0, s52
    v_pk_add_f32 v[194:195], v[176:177], 1.0 op_sel_hi:[1,0]
    v_pk_fma_f32 v[192:193], v[144:145], v[178:179], v[144:145]
    v_pk_fma_f32 v[192:193], v[146:147], v[194:195], v[192:193]
    v_pk_fma_f32 v[194:195], v[194:195], v[178:179], v[194:195]
    v_pk_fma_f32 v[192:193], v[192:193], v[180:181], v[192:193]
    v_pk_fma_f32 v[192:193], v[148:149], v[194:195], v[192:193]
    v_pk_fma_f32 v[194:195], v[194:195], v[180:181], v[194:195]
    v_pk_fma_f32 v[192:193], v[192:193], v[182:183], v[192:193]
    v_pk_fma_f32 v[192:193], v[150:151], v[194:195], v[192:193]
    v_pk_fma_f32 v[194:195], v[194:195], v[182:183], v[194:195]
    v_pk_fma_f32 v[192:193], v[192:193], v[184:185], v[192:193]
    v_pk_fma_f32 v[192:193], v[152:153], v[194:195], v[192:193]
    v_pk_fma_f32 v[194:195], v[194:195], v[184:185], v[194:195]
    v_pk_fma_f32 v[192:193], v[192:193], v[186:187], v[192:193]
    v_pk_fma_f32 v[192:193], v[154:155], v[194:195], v[192:193]
    v_pk_fma_f32 v[194:195], v[194:195], v[186:187], v[194:195]
    v_pk_fma_f32 v[192:193], v[192:193], v[188:189], v[192:193]
    v_pk_fma_f32 v[192:193], v[156:157], v[194:195], v[192:193]
    v_pk_fma_f32 v[194:195], v[194:195], v[188:189], v[194:195]
    v_pk_fma_f32 v[192:193], v[192:193], v[190:191], v[192:193]
    v_pk_fma_f32 v[192:193], v[158:159], v[194:195], v[192:193]
    v_pk_fma_f32 v[194:195], v[194:195], v[190:191], v[194:195]
    s_setprio 1
    v_exp_f32 v176, v160
    v_exp_f32 v177, v161
    v_exp_f32 v178, v162
    v_exp_f32 v179, v163
    v_exp_f32 v180, v164
    v_exp_f32 v181, v165
    v_exp_f32 v182, v166
    v_exp_f32_e64 v183, v167
    v_mfma_f32_32x32x16_bf16 v[144:159], v[88:91], v[48:51], v[216:231]
    v_exp_f32 v184, v168
    v_exp_f32 v185, v169
    v_exp_f32 v186, v170
    v_exp_f32 v187, v171
    v_exp_f32 v188, v172
    v_exp_f32 v189, v173
    v_exp_f32 v190, v174
    v_exp_f32_e64 v191, v175
    s_waitcnt vmcnt(4)
    ds_read_b64_tr_b16 v[56:57], v12 offset:0
    ds_read_b64_tr_b16 v[58:59], v12 offset:256
    ds_read_b64_tr_b16 v[60:61], v12 offset:1024
    ds_read_b64_tr_b16 v[62:63], v12 offset:1280
    ds_read_b64_tr_b16 v[64:65], v12 offset:2048
    ds_read_b64_tr_b16 v[66:67], v12 offset:2304
    ds_read_b64_tr_b16 v[68:69], v12 offset:3072
    ds_read_b64_tr_b16 v[70:71], v12 offset:3328
    ds_read_b64_tr_b16 v[72:73], v12 offset:64
    ds_read_b64_tr_b16 v[74:75], v12 offset:320
    ds_read_b64_tr_b16 v[76:77], v12 offset:1088
    ds_read_b64_tr_b16 v[78:79], v12 offset:1344
    ds_read_b64_tr_b16 v[80:81], v12 offset:2112
    ds_read_b64_tr_b16 v[82:83], v12 offset:2368
    ds_read_b64_tr_b16 v[84:85], v12 offset:3136
    ds_read_b64_tr_b16 v[86:87], v12 offset:3392
    ds_read_u16 v16, v4 offset:256
    ds_read_u16 v18, v4 offset:288
    ds_read_u16 v20, v4 offset:320
    ds_read_u16 v22, v4 offset:352
    s_setprio 0
    s_add_u32 s51, s51, 1
    v_pk_add_f32 v[196:197], v[176:177], 1.0 op_sel_hi:[1,0]
    v_pk_fma_f32 v[32:33], v[160:161], v[178:179], v[160:161]
    v_pk_fma_f32 v[32:33], v[162:163], v[196:197], v[32:33]
    v_pk_fma_f32 v[196:197], v[196:197], v[178:179], v[196:197]
    v_pk_fma_f32 v[32:33], v[32:33], v[180:181], v[32:33]
    v_pk_fma_f32 v[32:33], v[164:165], v[196:197], v[32:33]
    v_pk_fma_f32 v[196:197], v[196:197], v[180:181], v[196:197]
    v_pk_fma_f32 v[32:33], v[32:33], v[182:183], v[32:33]
    v_pk_fma_f32 v[32:33], v[166:167], v[196:197], v[32:33]
    v_pk_fma_f32 v[196:197], v[196:197], v[182:183], v[196:197]
    v_pk_fma_f32 v[32:33], v[32:33], v[184:185], v[32:33]
    v_pk_fma_f32 v[32:33], v[168:169], v[196:197], v[32:33]
    v_pk_fma_f32 v[196:197], v[196:197], v[184:185], v[196:197]
    v_pk_fma_f32 v[32:33], v[32:33], v[186:187], v[32:33]
    v_pk_fma_f32 v[32:33], v[170:171], v[196:197], v[32:33]
    v_pk_fma_f32 v[196:197], v[196:197], v[186:187], v[196:197]
    v_pk_fma_f32 v[32:33], v[32:33], v[188:189], v[32:33]
    v_pk_fma_f32 v[32:33], v[172:173], v[196:197], v[32:33]
    v_pk_fma_f32 v[196:197], v[196:197], v[188:189], v[196:197]
    v_pk_fma_f32 v[32:33], v[32:33], v[190:191], v[32:33]
    v_pk_fma_f32 v[32:33], v[174:175], v[196:197], v[32:33]
    v_pk_fma_f32 v[196:197], v[196:197], v[190:191], v[196:197]
    v_pk_mul_f32 v[34:35], v[194:195], v[196:197]
    v_cmp_ne_u32 s[74:75], v96, v14
    v_cmp_ne_u32 s[76:77], v97, v15
    v_rcp_f32 v198, v34
    v_rcp_f32 v199, v35
    s_setprio 1
    v_exp_f32 v176, v144
    v_exp_f32 v177, v145
    v_exp_f32 v178, v146
    v_exp_f32 v179, v147
    v_exp_f32 v180, v148
    v_exp_f32_e64 v181, v149
    v_mfma_f32_32x32x16_bf16 v[160:175], v[88:91], v[52:55], v[232:247]
    v_exp_f32 v182, v150
    v_exp_f32 v183, v151
    v_exp_f32 v184, v152
    v_exp_f32 v185, v153
    v_exp_f32 v186, v154
    v_exp_f32 v187, v155
    v_exp_f32 v188, v156
    v_exp_f32 v189, v157
    v_exp_f32 v190, v158
    v_exp_f32_e64 v191, v159
    s_or_b64 s[78:79], s[74:75], s[76:77]
    v_pk_mul_f32 v[192:193], v[192:193], v[196:197]
    v_pk_mul_f32 v[32:33], v[32:33], v[194:195]
    v_pk_fma_f32 v[200:201], v[192:193], v[198:199], v[200:201]
    v_pk_fma_f32 v[202:203], v[32:33], v[198:199], v[202:203]
    s_waitcnt lgkmcnt(0)
    s_cbranch_scc1 K2_qF0
K2_qrF0:
    buffer_load_dwordx4 v[16:17], s[16:19], 0 idxen offen offset:0 sc1 lds
    buffer_load_dwordx4 v[18:19], s[16:19], 0 idxen offen offset:1024 sc1 lds
    buffer_load_dwordx4 v[20:21], s[16:19], 0 idxen offen offset:2048 sc1 lds
    buffer_load_dwordx4 v[22:23], s[16:19], 0 idxen offen offset:3072 sc1 lds
    s_setprio 0
    s_mov_b32 m0, s14
    v_pk_add_f32 v[194:195], v[176:177], 1.0 op_sel_hi:[1,0]
    v_pk_fma_f32 v[192:193], v[144:145], v[178:179], v[144:145]
    v_pk_fma_f32 v[192:193], v[146:147], v[194:195], v[192:193]
    v_pk_fma_f32 v[194:195], v[194:195], v[178:179], v[194:195]
    v_pk_fma_f32 v[192:193], v[192:193], v[180:181], v[192:193]
    v_pk_fma_f32 v[192:193], v[148:149], v[194:195], v[192:193]
    v_pk_fma_f32 v[194:195], v[194:195], v[180:181], v[194:195]
    v_pk_fma_f32 v[192:193], v[192:193], v[182:183], v[192:193]
    v_pk_fma_f32 v[192:193], v[150:151], v[194:195], v[192:193]
    v_pk_fma_f32 v[194:195], v[194:195], v[182:183], v[194:195]
    v_pk_fma_f32 v[192:193], v[192:193], v[184:185], v[192:193]
    v_pk_fma_f32 v[192:193], v[152:153], v[194:195], v[192:193]
    v_pk_fma_f32 v[194:195], v[194:195], v[184:185], v[194:195]
    v_pk_fma_f32 v[192:193], v[192:193], v[186:187], v[192:193]
    v_pk_fma_f32 v[192:193], v[154:155], v[194:195], v[192:193]
    v_pk_fma_f32 v[194:195], v[194:195], v[186:187], v[194:195]
    v_pk_fma_f32 v[192:193], v[192:193], v[188:189], v[192:193]
    v_pk_fma_f32 v[192:193], v[156:157], v[194:195], v[192:193]
    v_pk_fma_f32 v[194:195], v[194:195], v[188:189], v[194:195]
    v_pk_fma_f32 v[192:193], v[192:193], v[190:191], v[192:193]
    v_pk_fma_f32 v[192:193], v[158:159], v[194:195], v[192:193]
    v_pk_fma_f32 v[194:195], v[194:195], v[190:191], v[194:195]
    s_setprio 1
    v_exp_f32 v176, v160
    v_exp_f32 v177, v161
    v_exp_f32 v178, v162
    v_exp_f32 v179, v163
    v_exp_f32 v180, v164
    v_exp_f32 v181, v165
    v_exp_f32 v182, v166
    v_exp_f32 v183, v167
    s_waitcnt lgkmcnt(0)
    v_mfma_f32_32x32x16_bf16 v[144:159], v[92:95], v[40:43], v[56:71]
    v_exp_f32 v184, v168
    v_exp_f32 v185, v169
    v_exp_f32 v186, v170
    v_exp_f32 v187, v171
    v_exp_f32 v188, v172
    v_exp_f32 v189, v173
    v_exp_f32 v190, v174
    v_exp_f32_e64 v191, v175
    s_waitcnt vmcnt(4)
    ds_read_b64_tr_b16 v[216:217], v12 offset:4096
    ds_read_b64_tr_b16 v[218:219], v12 offset:4352
    ds_read_b64_tr_b16 v[220:221], v12 offset:5120
    ds_read_b64_tr_b16 v[222:223], v12 offset:5376
    ds_read_b64_tr_b16 v[224:225], v12 offset:6144
    ds_read_b64_tr_b16 v[226:227], v12 offset:6400
    ds_read_b64_tr_b16 v[228:229], v12 offset:7168
    ds_read_b64_tr_b16 v[230:231], v12 offset:7424
    ds_read_b64_tr_b16 v[232:233], v12 offset:4160
    ds_read_b64_tr_b16 v[234:235], v12 offset:4416
    ds_read_b64_tr_b16 v[236:237], v12 offset:5184
    ds_read_b64_tr_b16 v[238:239], v12 offset:5440
    ds_read_b64_tr_b16 v[240:241], v12 offset:6208
    ds_read_b64_tr_b16 v[242:243], v12 offset:6464
    ds_read_b64_tr_b16 v[244:245], v12 offset:7232
    ds_read_b64_tr_b16 v[246:247], v12 offset:7488
    ds_read_u16 v96, v5 offset:256
    ds_read_u16 v97, v6 offset:256
    ds_read_b64 v[88:89], v3 offset:256
    s_mov_b64 exec, s[56:57]
    ds_read_b32 v90, v3 offset:268
    s_mov_b64 exec, s[58:59]
    ds_read_b32 v91, v3 offset:268
    s_mov_b64 exec, -1
    s_setprio 0
    v_pk_add_f32 v[196:197], v[176:177], 1.0 op_sel_hi:[1,0]
    v_pk_fma_f32 v[32:33], v[160:161], v[178:179], v[160:161]
    v_pk_fma_f32 v[32:33], v[162:163], v[196:197], v[32:33]
    v_pk_fma_f32 v[196:197], v[196:197], v[178:179], v[196:197]
    v_pk_fma_f32 v[32:33], v[32:33], v[180:181], v[32:33]
    v_pk_fma_f32 v[32:33], v[164:165], v[196:197], v[32:33]
    v_pk_fma_f32 v[196:197], v[196:197], v[180:181], v[196:197]
    v_pk_fma_f32 v[32:33], v[32:33], v[182:183], v[32:33]
    v_pk_fma_f32 v[32:33], v[166:167], v[196:197], v[32:33]
    v_pk_fma_f32 v[196:197], v[196:197], v[182:183], v[196:197]
    v_pk_fma_f32 v[32:33], v[32:33], v[184:185], v[32:33]
    v_pk_fma_f32 v[32:33], v[168:169], v[196:197], v[32:33]
    v_pk_fma_f32 v[196:197], v[196:197], v[184:185], v[196:197]
    v_pk_fma_f32 v[32:33], v[32:33], v[186:187], v[32:33]
    v_pk_fma_f32 v[32:33], v[170:171], v[196:197], v[32:33]
    v_pk_fma_f32 v[196:197], v[196:197], v[186:187], v[196:197]
    v_pk_fma_f32 v[32:33], v[32:33], v[188:189], v[32:33]
    v_pk_fma_f32 v[32:33], v[172:173], v[196:197], v[32:33]
    v_pk_fma_f32 v[196:197], v[196:197], v[188:189], v[196:197]
    v_pk_fma_f32 v[32:33], v[32:33], v[190:191], v[32:33]
    v_pk_fma_f32 v[32:33], v[174:175], v[196:197], v[32:33]
    v_pk_fma_f32 v[196:197], v[196:197], v[190:191], v[196:197]
    v_pk_mul_f32 v[36:37], v[194:195], v[196:197]
    s_cmp_lt_u32 s51, s50
    s_cbranch_scc0 K2_tail
    v_rcp_f32 v198, v36
    v_rcp_f32 v199, v37
    s_setprio 1
    v_exp_f32 v176, v144
    v_exp_f32 v177, v145
    v_exp_f32 v178, v146
    v_exp_f32 v179, v147
    v_exp_f32 v180, v148
    v_exp_f32_e64 v181, v149
    v_mfma_f32_32x32x16_bf16 v[160:175], v[92:95], v[44:47], v[72:87]
    v_exp_f32 v182, v150
    v_exp_f32 v183, v151
    v_exp_f32 v184, v152
    v_exp_f32 v185, v153
    v_exp_f32 v186, v154
    v_exp_f32 v187, v155
    v_exp_f32 v188, v156
    v_exp_f32 v189, v157
    v_exp_f32 v190, v158
    v_exp_f32_e64 v191, v159
    s_cmp_lg_u64 s[78:79], 0
    v_pk_mul_f32 v[192:193], v[192:193], v[196:197]
    v_pk_mul_f32 v[32:33], v[32:33], v[194:195]
    v_pk_fma_f32 v[204:205], v[192:193], v[198:199], v[204:205]
    v_pk_fma_f32 v[206:207], v[32:33], v[198:199], v[206:207]
    v_pk_fma_f32 v[30:31], v[34:35], v[36:37], v[30:31]
    s_waitcnt lgkmcnt(0)
    s_cbranch_scc1 K2_flF1
K2_flrF1:
    buffer_load_dwordx4 v[16:17], s[16:19], s15 idxen offen offset:0 sc1 lds
    buffer_load_dwordx4 v[18:19], s[16:19], s15 idxen offen offset:1024 sc1 lds
    buffer_load_dwordx4 v[20:21], s[16:19], s15 idxen offen offset:2048 sc1 lds
    buffer_load_dwordx4 v[22:23], s[16:19], s15 idxen offen offset:3072 sc1 lds
    s_setprio 0
    s_mov_b32 m0, s52
    v_pk_add_f32 v[194:195], v[176:177], 1.0 op_sel_hi:[1,0]
    v_pk_fma_f32 v[192:193], v[144:145], v[178:179], v[144:145]
    v_pk_fma_f32 v[192:193], v[146:147], v[194:195], v[192:193]
    v_pk_fma_f32 v[194:195], v[194:195], v[178:179], v[194:195]
    v_pk_fma_f32 v[192:193], v[192:193], v[180:181], v[192:193]
    v_pk_fma_f32 v[192:193], v[148:149], v[194:195], v[192:193]
    v_pk_fma_f32 v[194:195], v[194:195], v[180:181], v[194:195]
    v_pk_fma_f32 v[192:193], v[192:193], v[182:183], v[192:193]
    v_pk_fma_f32 v[192:193], v[150:151], v[194:195], v[192:193]
    v_pk_fma_f32 v[194:195], v[194:195], v[182:183], v[194:195]
    v_pk_fma_f32 v[192:193], v[192:193], v[184:185], v[192:193]
    v_pk_fma_f32 v[192:193], v[152:153], v[194:195], v[192:193]
    v_pk_fma_f32 v[194:195], v[194:195], v[184:185], v[194:195]
    v_pk_fma_f32 v[192:193], v[192:193], v[186:187], v[192:193]
    v_pk_fma_f32 v[192:193], v[154:155], v[194:195], v[192:193]
    v_pk_fma_f32 v[194:195], v[194:195], v[186:187], v[194:195]
    v_pk_fma_f32 v[192:193], v[192:193], v[188:189], v[192:193]
    v_pk_fma_f32 v[192:193], v[156:157], v[194:195], v[192:193]
    v_pk_fma_f32 v[194:195], v[194:195], v[188:189], v[194:195]
    v_pk_fma_f32 v[192:193], v[192:193], v[190:191], v[192:193]
    v_pk_fma_f32 v[192:193], v[158:159], v[194:195], v[192:193]
    v_pk_fma_f32 v[194:195], v[194:195], v[190:191], v[194:195]
    s_setprio 1
    v_exp_f32 v176, v160
    v_exp_f32 v177, v161
    v_exp_f32 v178, v162
    v_exp_f32 v179, v163
    v_exp_f32 v180, v164
    v_exp_f32 v181, v165
    v_exp_f32 v182, v166
    v_exp_f32_e64 v183, v167
    v_mfma_f32_32x32x16_bf16 v[144:159], v[92:95], v[48:51], v[216:231]
    v_exp_f32 v184, v168
    v_exp_f32 v185, v169
    v_exp_f32 v186, v170
    v_exp_f32 v187, v171
    v_exp_f32 v188, v172
    v_exp_f32 v189, v173
    v_exp_f32 v190, v174
    v_exp_f32_e64 v191, v175
    s_waitcnt vmcnt(4)
    ds_read_b64_tr_b16 v[56:57], v12 offset:0
    ds_read_b64_tr_b16 v[58:59], v12 offset:256
    ds_read_b64_tr_b16 v[60:61], v12 offset:1024
    ds_read_b64_tr_b16 v[62:63], v12 offset:1280
    ds_read_b64_tr_b16 v[64:65], v12 offset:2048
    ds_read_b64_tr_b16 v[66:67], v12 offset:2304
    ds_read_b64_tr_b16 v[68:69], v12 offset:3072
    ds_read_b64_tr_b16 v[70:71], v12 offset:3328
    ds_read_b64_tr_b16 v[72:73], v12 offset:64
    ds_read_b64_tr_b16 v[74:75], v12 offset:320
    ds_read_b64_tr_b16 v[76:77], v12 offset:1088
    ds_read_b64_tr_b16 v[78:79], v12 offset:1344
    ds_read_b64_tr_b16 v[80:81], v12 offset:2112
    ds_read_b64_tr_b16 v[82:83], v12 offset:2368
    ds_read_b64_tr_b16 v[84:85], v12 offset:3136
    ds_read_b64_tr_b16 v[86:87], v12 offset:3392
    ds_read_u16 v16, v4 offset:384
    ds_read_u16 v18, v4 offset:416
    ds_read_u16 v20, v4 offset:448
    ds_read_u16 v22, v4 offset:480
    s_setprio 0
    s_add_u32 s51, s51, 1
    v_pk_add_f32 v[196:197], v[176:177], 1.0 op_sel_hi:[1,0]
    v_pk_fma_f32 v[32:33], v[160:161], v[178:179], v[160:161]
    v_pk_fma_f32 v[32:33], v[162:163], v[196:197], v[32:33]
    v_pk_fma_f32 v[196:197], v[196:197], v[178:179], v[196:197]
    v_pk_fma_f32 v[32:33], v[32:33], v[180:181], v[32:33]
    v_pk_fma_f32 v[32:33], v[164:165], v[196:197], v[32:33]
    v_pk_fma_f32 v[196:197], v[196:197], v[180:181], v[196:197]
    v_pk_fma_f32 v[32:33], v[32:33], v[182:183], v[32:33]
    v_pk_fma_f32 v[32:33], v[166:167], v[196:197], v[32:33]
    v_pk_fma_f32 v[196:197], v[196:197], v[182:183], v[196:197]
    v_pk_fma_f32 v[32:33], v[32:33], v[184:185], v[32:33]
    v_pk_fma_f32 v[32:33], v[168:169], v[196:197], v[32:33]
    v_pk_fma_f32 v[196:197], v[196:197], v[184:185], v[196:197]
    v_pk_fma_f32 v[32:33], v[32:33], v[186:187], v[32:33]
    v_pk_fma_f32 v[32:33], v[170:171], v[196:197], v[32:33]
    v_pk_fma_f32 v[196:197], v[196:197], v[186:187], v[196:197]
    v_pk_fma_f32 v[32:33], v[32:33], v[188:189], v[32:33]
    v_pk_fma_f32 v[32:33], v[172:173], v[196:197], v[32:33]
    v_pk_fma_f32 v[196:197], v[196:197], v[188:189], v[196:197]
    v_pk_fma_f32 v[32:33], v[32:33], v[190:191], v[32:33]
    v_pk_fma_f32 v[32:33], v[174:175], v[196:197], v[32:33]
    v_pk_fma_f32 v[196:197], v[196:197], v[190:191], v[196:197]
    v_pk_mul_f32 v[34:35], v[194:195], v[196:197]
    v_cmp_ne_u32 s[74:75], v96, v14
    v_cmp_ne_u32 s[76:77], v97, v15
    v_rcp_f32 v198, v34
    v_rcp_f32 v199, v35
    s_setprio 1
    v_exp_f32 v176, v144
    v_exp_f32 v177, v145
    v_exp_f32 v178, v146
    v_exp_f32 v179, v147
    v_exp_f32 v180, v148
    v_exp_f32_e64 v181, v149
    v_mfma_f32_32x32x16_bf16 v[160:175], v[92:95], v[52:55], v[232:247]
    v_exp_f32 v182, v150
    v_exp_f32 v183, v151
    v_exp_f32 v184, v152
    v_exp_f32 v185, v153
    v_exp_f32 v186, v154
    v_exp_f32 v187, v155
    v_exp_f32 v188, v156
    v_exp_f32 v189, v157
    v_exp_f32 v190, v158
    v_exp_f32_e64 v191, v159
    s_or_b64 s[78:79], s[74:75], s[76:77]
    v_pk_mul_f32 v[192:193], v[192:193], v[196:197]
    v_pk_mul_f32 v[32:33], v[32:33], v[194:195]
    v_pk_fma_f32 v[200:201], v[192:193], v[198:199], v[200:201]
    v_pk_fma_f32 v[202:203], v[32:33], v[198:199], v[202:203]
    s_waitcnt lgkmcnt(0)
    s_cbranch_scc1 K2_qF1
K2_qrF1:
    buffer_load_dwordx4 v[16:17], s[16:19], 0 idxen offen offset:0 sc1 lds
    buffer_load_dwordx4 v[18:19], s[16:19], 0 idxen offen offset:1024 sc1 lds
    buffer_load_dwordx4 v[20:21], s[16:19], 0 idxen offen offset:2048 sc1 lds
    buffer_load_dwordx4 v[22:23], s[16:19], 0 idxen offen offset:3072 sc1 lds
    s_setprio 0
    s_mov_b32 m0, s14
    v_pk_add_f32 v[194:195], v[176:177], 1.0 op_sel_hi:[1,0]
    v_pk_fma_f32 v[192:193], v[144:145], v[178:179], v[144:145]
    v_pk_fma_f32 v[192:193], v[146:147], v[194:195], v[192:193]
    v_pk_fma_f32 v[194:195], v[194:195], v[178:179], v[194:195]
    v_pk_fma_f32 v[192:193], v[192:193], v[180:181], v[192:193]
    v_pk_fma_f32 v[192:193], v[148:149], v[194:195], v[192:193]
    v_pk_fma_f32 v[194:195], v[194:195], v[180:181], v[194:195]
    v_pk_fma_f32 v[192:193], v[192:193], v[182:183], v[192:193]
    v_pk_fma_f32 v[192:193], v[150:151], v[194:195], v[192:193]
    v_pk_fma_f32 v[194:195], v[194:195], v[182:183], v[194:195]
    v_pk_fma_f32 v[192:193], v[192:193], v[184:185], v[192:193]
    v_pk_fma_f32 v[192:193], v[152:153], v[194:195], v[192:193]
    v_pk_fma_f32 v[194:195], v[194:195], v[184:185], v[194:195]
    v_pk_fma_f32 v[192:193], v[192:193], v[186:187], v[192:193]
    v_pk_fma_f32 v[192:193], v[154:155], v[194:195], v[192:193]
    v_pk_fma_f32 v[194:195], v[194:195], v[186:187], v[194:195]
    v_pk_fma_f32 v[192:193], v[192:193], v[188:189], v[192:193]
    v_pk_fma_f32 v[192:193], v[156:157], v[194:195], v[192:193]
    v_pk_fma_f32 v[194:195], v[194:195], v[188:189], v[194:195]
    v_pk_fma_f32 v[192:193], v[192:193], v[190:191], v[192:193]
    v_pk_fma_f32 v[192:193], v[158:159], v[194:195], v[192:193]
    v_pk_fma_f32 v[194:195], v[194:195], v[190:191], v[194:195]
    s_setprio 1
    v_exp_f32 v176, v160
    v_exp_f32 v177, v161
    v_exp_f32 v178, v162
    v_exp_f32 v179, v163
    v_exp_f32 v180, v164
    v_exp_f32 v181, v165
    v_exp_f32 v182, v166
    v_exp_f32 v183, v167
    s_waitcnt lgkmcnt(0)
    v_mfma_f32_32x32x16_bf16 v[144:159], v[88:91], v[40:43], v[56:71]
    v_exp_f32 v184, v168
    v_exp_f32 v185, v169
    v_exp_f32 v186, v170
    v_exp_f32 v187, v171
    v_exp_f32 v188, v172
    v_exp_f32 v189, v173
    v_exp_f32 v190, v174
    v_exp_f32_e64 v191, v175
    s_waitcnt vmcnt(4)
    ds_read_b64_tr_b16 v[216:217], v12 offset:4096
    ds_read_b64_tr_b16 v[218:219], v12 offset:4352
    ds_read_b64_tr_b16 v[220:221], v12 offset:5120
    ds_read_b64_tr_b16 v[222:223], v12 offset:5376
    ds_read_b64_tr_b16 v[224:225], v12 offset:6144
    ds_read_b64_tr_b16 v[226:227], v12 offset:6400
    ds_read_b64_tr_b16 v[228:229], v12 offset:7168
    ds_read_b64_tr_b16 v[230:231], v12 offset:7424
    ds_read_b64_tr_b16 v[232:233], v12 offset:4160
    ds_read_b64_tr_b16 v[234:235], v12 offset:4416
    ds_read_b64_tr_b16 v[236:237], v12 offset:5184
    ds_read_b64_tr_b16 v[238:239], v12 offset:5440
    ds_read_b64_tr_b16 v[240:241], v12 offset:6208
    ds_read_b64_tr_b16 v[242:243], v12 offset:6464
    ds_read_b64_tr_b16 v[244:245], v12 offset:7232
    ds_read_b64_tr_b16 v[246:247], v12 offset:7488
    ds_read_u16 v14, v5 offset:384
    ds_read_u16 v15, v6 offset:384
    ds_read_b64 v[92:93], v3 offset:384
    s_mov_b64 exec, s[56:57]
    ds_read_b32 v94, v3 offset:396
    s_mov_b64 exec, s[58:59]
    ds_read_b32 v95, v3 offset:396
    s_mov_b64 exec, -1
    s_setprio 0
    v_pk_add_f32 v[196:197], v[176:177], 1.0 op_sel_hi:[1,0]
    v_pk_fma_f32 v[32:33], v[160:161], v[178:179], v[160:161]
    v_pk_fma_f32 v[32:33], v[162:163], v[196:197], v[32:33]
    v_pk_fma_f32 v[196:197], v[196:197], v[178:179], v[196:197]
    v_pk_fma_f32 v[32:33], v[32:33], v[180:181], v[32:33]
    v_pk_fma_f32 v[32:33], v[164:165], v[196:197], v[32:33]
    v_pk_fma_f32 v[196:197], v[196:197], v[180:181], v[196:197]
    v_pk_fma_f32 v[32:33], v[32:33], v[182:183], v[32:33]
    v_pk_fma_f32 v[32:33], v[166:167], v[196:197], v[32:33]
    v_pk_fma_f32 v[196:197], v[196:197], v[182:183], v[196:197]
    v_pk_fma_f32 v[32:33], v[32:33], v[184:185], v[32:33]
    v_pk_fma_f32 v[32:33], v[168:169], v[196:197], v[32:33]
    v_pk_fma_f32 v[196:197], v[196:197], v[184:185], v[196:197]
    v_pk_fma_f32 v[32:33], v[32:33], v[186:187], v[32:33]
    v_pk_fma_f32 v[32:33], v[170:171], v[196:197], v[32:33]
    v_pk_fma_f32 v[196:197], v[196:197], v[186:187], v[196:197]
    v_pk_fma_f32 v[32:33], v[32:33], v[188:189], v[32:33]
    v_pk_fma_f32 v[32:33], v[172:173], v[196:197], v[32:33]
    v_pk_fma_f32 v[196:197], v[196:197], v[188:189], v[196:197]
    v_pk_fma_f32 v[32:33], v[32:33], v[190:191], v[32:33]
    v_pk_fma_f32 v[32:33], v[174:175], v[196:197], v[32:33]
    v_pk_fma_f32 v[196:197], v[196:197], v[190:191], v[196:197]
    v_pk_mul_f32 v[36:37], v[194:195], v[196:197]
    v_add_u32 v3, 0x100, v3
    v_add_u32 v4, 0x100, v4
    v_add_u32 v5, 0x100, v5
    v_add_u32 v6, 0x100, v6
    s_cmp_lt_u32 s51, s50
    s_cbranch_scc1 K2_loopF
    s_branch K2_tail
    .p2align 3
K2_flF0:
    s_mov_b64 exec, s[74:75]
    s_cbranch_execz K2_fsF0
    ds_write2_b32 v26, v200, v202 offset0:0 offset1:32
    ds_write2_b32 v26, v204, v206 offset0:64 offset1:96
    v_mov_b32 v200, 0
    v_mov_b32 v202, 0
    v_mov_b32 v204, 0
    v_mov_b32 v206, 0
    v_lshl_add_u32 v26, v24, 1, v11
    s_mov_b64 exec, -1
    s_cmp_eq_u64 s[76:77], 0
    s_cbranch_scc1 K2_flrF0
K2_fsF0:
    s_mov_b64 exec, s[76:77]
    ds_write2_b32 v27, v201, v203 offset0:128 offset1:160
    ds_write2_b32 v27, v205, v207 offset0:192 offset1:224
    v_mov_b32 v201, 0
    v_mov_b32 v203, 0
    v_mov_b32 v205, 0
    v_mov_b32 v207, 0
    v_lshl_add_u32 v27, v25, 1, v11
    s_mov_b64 exec, -1
    s_branch K2_flrF0
    .p2align 3
K2_qF0:
    s_cmp_eq_u64 s[74:75], 0
    s_cbranch_scc1 K2_qsF0
    v_lshl_add_u32 v24, v14, 6, v251
    ds_read_u16_d16_hi v42, v24 offset:0
    ds_read_u16_d16_hi v46, v24 offset:64
    ds_read_u16_d16_hi v50, v24 offset:128
    ds_read_u16_d16_hi v54, v24 offset:192
K2_qsF0:
    s_cmp_eq_u64 s[76:77], 0
    s_cbranch_scc1 K2_qrF0
    v_lshl_add_u32 v25, v15, 6, v251
    ds_read_u16_d16_hi v43, v25 offset:0
    ds_read_u16_d16_hi v47, v25 offset:64
    ds_read_u16_d16_hi v51, v25 offset:128
    ds_read_u16_d16_hi v55, v25 offset:192
    s_branch K2_qrF0
    .p2align 3
K2_flF1:
    s_mov_b64 exec, s[74:75]
    s_cbranch_execz K2_fsF1
    ds_write2_b32 v26, v200, v202 offset0:0 offset1:32
    ds_write2_b32 v26, v204, v206 offset0:64 offset1:96
    v_mov_b32 v200, 0
    v_mov_b32 v202, 0
    v_mov_b32 v204, 0
    v_mov_b32 v206, 0
    v_lshl_add_u32 v26, v24, 1, v11
    s_mov_b64 exec, -1
    s_cmp_eq_u64 s[76:77], 0
    s_cbranch_scc1 K2_flrF1
K2_fsF1:
    s_mov_b64 exec, s[76:77]
    ds_write2_b32 v27, v201, v203 offset0:128 offset1:160
    ds_write2_b32 v27, v205, v207 offset0:192 offset1:224
    v_mov_b32 v201, 0
    v_mov_b32 v203, 0
    v_mov_b32 v205, 0
    v_mov_b32 v207, 0
    v_lshl_add_u32 v27, v25, 1, v11
    s_mov_b64 exec, -1
    s_branch K2_flrF1
    .p2align 3
K2_qF1:
    s_cmp_eq_u64 s[74:75], 0
    s_cbranch_scc1 K2_qsF1
    v_lshl_add_u32 v24, v96, 6, v251
    ds_read_u16_d16_hi v42, v24 offset:0
    ds_read_u16_d16_hi v46, v24 offset:64
    ds_read_u16_d16_hi v50, v24 offset:128
    ds_read_u16_d16_hi v54, v24 offset:192
K2_qsF1:
    s_cmp_eq_u64 s[76:77], 0
    s_cbranch_scc1 K2_qrF1
    v_lshl_add_u32 v25, v97, 6, v251
    ds_read_u16_d16_hi v43, v25 offset:0
    ds_read_u16_d16_hi v47, v25 offset:64
    ds_read_u16_d16_hi v51, v25 offset:128
    ds_read_u16_d16_hi v55, v25 offset:192
    s_branch K2_qrF1
K2_tail:
    v_rcp_f32 v198, v36
    v_rcp_f32 v199, v37
    s_nop 0
    v_pk_mul_f32 v[192:193], v[192:193], v[196:197]
    v_pk_mul_f32 v[32:33], v[32:33], v[194:195]
    v_pk_fma_f32 v[204:205], v[192:193], v[198:199], v[204:205]
    v_pk_fma_f32 v[206:207], v[32:33], v[198:199], v[206:207]
    v_pk_fma_f32 v[30:31], v[34:35], v[36:37], v[30:31]
    ds_write2_b32 v26, v200, v202 offset0:0 offset1:32
    ds_write2_b32 v27, v201, v203 offset0:128 offset1:160
    ds_write2_b32 v26, v204, v206 offset0:64 offset1:96
    ds_write2_b32 v27, v205, v207 offset0:192 offset1:224
K2_idle:
K2_nosetup2:
    s_setprio 3
    s_or_b32 s53, s2, s44
    s_cbranch_scc1 K2_noep
    v_mov_b32 v10, s40
    s_mov_b32 s38, 8
    s_mov_b64 exec, 1
    buffer_store_dword v10, v7, s[36:39], 0 offen
    s_mov_b64 exec, -1
    s_mov_b32 s38, 0
K2_noep:
    v_max_f32 v10, v30, v31
    v_add_f32 v8, v30, v31
    v_mov_b32 v192, 0
    v_cmp_le_f32 s[64:65], s10, v10
    v_mul_f32 v193, 0, v8
    s_waitcnt lgkmcnt(0)
    s_barrier
    ds_read_b128 v[144:147], v130 offset:10496
    ds_read_b128 v[148:151], v131 offset:10496
    ds_read_b128 v[152:155], v132 offset:10496
    ds_read_b128 v[156:159], v133 offset:10496
    ds_read_b128 v[160:163], v134 offset:10496
    ds_read_b128 v[164:167], v135 offset:10496
    ds_read_b128 v[168:171], v136 offset:10496
    ds_read_b128 v[172:175], v137 offset:10496
    ds_read_b128 v[176:179], v138 offset:10496
    s_mov_b64 exec, -1
    v_lshlrev_b32 v56, 16, v128
    v_and_b32 v57, 0xffff0000, v128
    v_lshlrev_b32 v58, 16, v129
    v_and_b32 v59, 0xffff0000, v129
    v_mul_f32 v72, v214, v56
    v_mul_f32 v73, v214, v57
    v_mul_f32 v74, v214, v58
    v_mul_f32 v75, v214, v59
    v_mul_f32 v76, v215, v56
    v_mul_f32 v77, v215, v57
    v_mul_f32 v78, v215, v58
    v_mul_f32 v79, v215, v59
    s_cmp_lg_u64 s[72:73], 0
    s_cbranch_scc1 K2_more0
    s_waitcnt lgkmcnt(6)
    v_pk_add_f32 v[144:145], v[144:145], v[148:149]
    v_pk_add_f32 v[146:147], v[146:147], v[150:151]
    v_pk_add_f32 v[144:145], v[144:145], v[152:153]
    v_pk_add_f32 v[146:147], v[146:147], v[154:155]
    v_pk_fma_f32 v[192:193], v[144:145], 0, v[192:193] op_sel_hi:[1,0,1]
    v_pk_fma_f32 v[192:193], v[146:147], 0, v[192:193] op_sel_hi:[1,0,1]
    v_cvt_pk_bf16_f32 v144, v144, v145
    v_cvt_pk_bf16_f32 v145, v146, v147
    ds_write_b64 v208, v[144:145] offset:0
    s_waitcnt lgkmcnt(4)
    v_pk_add_f32 v[156:157], v[156:157], v[160:161]
    v_pk_add_f32 v[158:159], v[158:159], v[162:163]
    v_pk_add_f32 v[156:157], v[156:157], v[164:165]
    v_pk_add_f32 v[158:159], v[158:159], v[166:167]
    v_pk_fma_f32 v[192:193], v[156:157], 0, v[192:193] op_sel_hi:[1,0,1]
    v_pk_fma_f32 v[192:193], v[158:159], 0, v[192:193] op_sel_hi:[1,0,1]
    v_cvt_pk_bf16_f32 v156, v156, v157
    v_cvt_pk_bf16_f32 v157, v158, v159
    ds_write_b64 v208, v[156:157] offset:4352
    s_waitcnt lgkmcnt(2)
    v_pk_add_f32 v[168:169], v[168:169], v[172:173]
    v_pk_add_f32 v[170:171], v[170:171], v[174:175]
    v_pk_add_f32 v[168:169], v[168:169], v[176:177]
    v_pk_add_f32 v[170:171], v[170:171], v[178:179]
    v_pk_fma_f32 v[192:193], v[168:169], 0, v[192:193] op_sel_hi:[1,0,1]
    v_pk_fma_f32 v[192:193], v[170:171], 0, v[192:193] op_sel_hi:[1,0,1]
    v_cvt_pk_bf16_f32 v168, v168, v169
    v_cvt_pk_bf16_f32 v169, v170, v171
    ds_write_b64 v208, v[168:169] offset:8704
K2_folded:
    v_cmp_u_f32 vcc, v192, v193
    s_add_u32 s45, s45, s46
    s_lshl_b32 s51, s45, 2
    s_or_b64 s[64:65], s[64:65], vcc
    s_cbranch_scc1 K2_flag
K2_noflag:
    s_waitcnt lgkmcnt(0)
    s_barrier
    ds_read_b32 v8, v212 offset:48132
    ds_read_b128 v[144:147], v209 offset:0
    ds_read_b128 v[148:151], v209 offset:64
    ds_read_b128 v[152:155], v209 offset:128
    ds_read_b128 v[156:159], v209 offset:192
    s_cmp_ge_u32 s44, 4
    s_cbranch_scc1 K2_one
    ds_read_b128 v[160:163], v209 offset:8704
    ds_read_b128 v[164:167], v209 offset:8768
    ds_read_b128 v[168:171], v209 offset:8832
    ds_read_b128 v[172:175], v209 offset:8896
    s_waitcnt lgkmcnt(7)
    v_mfma_f32_16x16x32_bf16 v[104:107], v[112:115], v[144:147], v[104:107]
    s_waitcnt lgkmcnt(6)
    v_mfma_f32_16x16x32_bf16 v[104:107], v[116:119], v[148:151], v[104:107]
    s_waitcnt lgkmcnt(5)
    v_mfma_f32_16x16x32_bf16 v[104:107], v[120:123], v[152:155], v[104:107]
    s_waitcnt lgkmcnt(4)
    v_mfma_f32_16x16x32_bf16 v[104:107], v[124:127], v[156:159], v[104:107]
    s_waitcnt lgkmcnt(3)
    v_mfma_f32_16x16x32_bf16 v[108:111], v[112:115], v[160:163], v[108:111]
    s_waitcnt lgkmcnt(2)
    v_mfma_f32_16x16x32_bf16 v[108:111], v[116:119], v[164:167], v[108:111]
    s_waitcnt lgkmcnt(1)
    v_mfma_f32_16x16x32_bf16 v[108:111], v[120:123], v[168:171], v[108:111]
    s_waitcnt lgkmcnt(0)
    v_mfma_f32_16x16x32_bf16 v[108:111], v[124:127], v[172:175], v[108:111]
    s_branch K2_two
K2_one:
    s_waitcnt lgkmcnt(3)
    v_mfma_f32_16x16x32_bf16 v[104:107], v[112:115], v[144:147], v[104:107]
    s_waitcnt lgkmcnt(2)
    v_mfma_f32_16x16x32_bf16 v[104:107], v[116:119], v[148:151], v[104:107]
    s_waitcnt lgkmcnt(1)
    v_mfma_f32_16x16x32_bf16 v[104:107], v[120:123], v[152:155], v[104:107]
    s_waitcnt lgkmcnt(0)
    v_mfma_f32_16x16x32_bf16 v[104:107], v[124:127], v[156:159], v[104:107]
K2_two:
    v_readfirstlane_b32 s53, v8
    s_mov_b64 exec, s[68:69]
    s_nop 2
    s_cmp_gt_u32 s53, s48
    s_cbranch_scc1 K2_redo
    s_cmp_lt_u32 s51, s49
    s_cbranch_scc1 K2_next
    v_fma_f32 v72, v104, s96, v72
    v_fma_f32 v73, v105, s96, v73
    v_fma_f32 v74, v106, s96, v74
    v_fma_f32 v75, v107, s96, v75
    v_cvt_pk_bf16_f32 v60, v72, v73
    v_cvt_pk_bf16_f32 v61, v74, v75
    buffer_store_dwordx2 v[60:61], v210, s[32:35], s7 offen
    s_mov_b64 exec, s[70:71]
    s_cbranch_execz K2_done
    v_fma_f32 v76, v108, s96, v76
    v_fma_f32 v77, v109, s96, v77
    v_fma_f32 v78, v110, s96, v78
    v_fma_f32 v79, v111, s96, v79
    v_cvt_pk_bf16_f32 v62, v76, v77
    v_cvt_pk_bf16_f32 v63, v78, v79
    buffer_store_dwordx2 v[62:63], v210, s[32:35], s8 offen
K2_done:
K2_exit:
    s_endpgm
K2_hot_end:
K2_dretry:
    s_cmp_gt_u32 s43, 1048576
    s_cbranch_scc1 K2_exit
    s_branch K2_dpoll
K2_flag:
    v_mov_b32 v8, 1
    ds_write_b32 v212, v8 offset:48132
    s_branch K2_noflag
K2_redo:
    s_mov_b32 s48, 1
    s_mov_b32 s45, 0
    s_mov_b32 s47, 1
K2_next:
    s_mov_b64 exec, -1
    s_waitcnt vmcnt(0)
    s_barrier
    s_branch K2_round
K2_more0:
    ds_read_b128 v[168:171], v136 offset:10496
    ds_read_b128 v[172:175], v137 offset:10496
    ds_read_b128 v[176:179], v138 offset:10496
    s_waitcnt lgkmcnt(0)
    v_pk_add_f32 v[144:145], v[144:145], v[148:149]
    v_pk_add_f32 v[146:147], v[146:147], v[150:151]
    v_pk_add_f32 v[144:145], v[144:145], v[152:153]
    v_pk_add_f32 v[146:147], v[146:147], v[154:155]
    v_pk_add_f32 v[156:157], v[156:157], v[160:161]
    v_pk_add_f32 v[158:159], v[158:159], v[162:163]
    v_pk_add_f32 v[156:157], v[156:157], v[164:165]
    v_pk_add_f32 v[158:159], v[158:159], v[166:167]
    v_pk_add_f32 v[168:169], v[168:169], v[172:173]
    v_pk_add_f32 v[170:171], v[170:171], v[174:175]
    v_pk_add_f32 v[168:169], v[168:169], v[176:177]
    v_pk_add_f32 v[170:171], v[170:171], v[178:179]
    s_mov_b32 s53, 3
K2_more:
    v_cmp_lt_u32 vcc, s53, v139
    v_add_u32 v132, 0x200, v132
    s_mov_b64 exec, vcc
    ds_read_b128 v[148:151], v132 offset:10496
    s_waitcnt lgkmcnt(0)
    v_pk_add_f32 v[144:145], v[144:145], v[148:149]
    v_pk_add_f32 v[146:147], v[146:147], v[150:151]
    s_mov_b64 exec, -1
    v_cmp_lt_u32 vcc, s53, v140
    v_add_u32 v135, 0x200, v135
    s_mov_b64 exec, vcc
    ds_read_b128 v[160:163], v135 offset:10496
    s_waitcnt lgkmcnt(0)
    v_pk_add_f32 v[156:157], v[156:157], v[160:161]
    v_pk_add_f32 v[158:159], v[158:159], v[162:163]
    s_mov_b64 exec, -1
    v_cmp_lt_u32 vcc, s53, v141
    v_add_u32 v138, 0x200, v138
    s_mov_b64 exec, vcc
    ds_read_b128 v[172:175], v138 offset:10496
    s_waitcnt lgkmcnt(0)
    v_pk_add_f32 v[168:169], v[168:169], v[172:173]
    v_pk_add_f32 v[170:171], v[170:171], v[174:175]
    s_mov_b64 exec, -1
    s_add_u32 s53, s53, 1
    v_cmp_lt_u32 vcc, s53, v211
    s_cbranch_vccnz K2_more
    v_pk_fma_f32 v[192:193], v[144:145], 0, v[192:193] op_sel_hi:[1,0,1]
    v_pk_fma_f32 v[192:193], v[146:147], 0, v[192:193] op_sel_hi:[1,0,1]
    v_cvt_pk_bf16_f32 v144, v144, v145
    v_cvt_pk_bf16_f32 v145, v146, v147
    ds_write_b64 v208, v[144:145] offset:0
    v_pk_fma_f32 v[192:193], v[156:157], 0, v[192:193] op_sel_hi:[1,0,1]
    v_pk_fma_f32 v[192:193], v[158:159], 0, v[192:193] op_sel_hi:[1,0,1]
    v_cvt_pk_bf16_f32 v156, v156, v157
    v_cvt_pk_bf16_f32 v157, v158, v159
    ds_write_b64 v208, v[156:157] offset:4352
    v_pk_fma_f32 v[192:193], v[168:169], 0, v[192:193] op_sel_hi:[1,0,1]
    v_pk_fma_f32 v[192:193], v[170:171], 0, v[192:193] op_sel_hi:[1,0,1]
    v_cvt_pk_bf16_f32 v168, v168, v169
    v_cvt_pk_bf16_f32 v169, v170, v171
    ds_write_b64 v208, v[168:169] offset:8704
    s_branch K2_folded
K2_nofit:
    s_mov_b32 s46, 8
    s_waitcnt vmcnt(0) lgkmcnt(0)
    s_barrier
    s_branch K2_round
K2_round:
    v_mov_b32 v56, 0
    v_mov_b32 v57, 0
    v_mov_b32 v58, 0
    v_mov_b32 v59, 0
    v_lshlrev_b32 v9, 4, v0
    v_cmp_gt_u32 vcc, 32, v0
    v_mov_b32 v61, 0x3f803f80
    v_add_u32 v8, 113932, v9
    s_mov_b64 exec, vcc
    ds_write_b128 v9, v[56:59] offset:46848
    ds_write_b128 v9, v[56:59] offset:10240
    s_mov_b64 exec, -1
    ds_write_b32 v8, v61 offset:0
    ds_write_b32 v8, v61 offset:8192
    ds_write_b32 v8, v61 offset:16384
    ds_write_b32 v8, v61 offset:24576
    ds_write_b32 v8, v61 offset:32768
    ds_write_b32 v8, v61 offset:40960
    s_cmp_eq_u32 s47, 0
    s_cbranch_scc1 K2_notfirstb
    ds_write_b32 v101, v56 offset:47872
    v_mov_b32 v30, 0
    v_mov_b32 v31, 0
    v_mov_b32 v104, 0
    v_mov_b32 v105, 0
    v_mov_b32 v106, 0
    v_mov_b32 v107, 0
    v_mov_b32 v108, 0
    v_mov_b32 v109, 0
    v_mov_b32 v110, 0
    v_mov_b32 v111, 0
K2_notfirstb:
    v_and_b32 v130, 15, v0
    v_add_u32 v8, 16, v130
    v_cmp_gt_u32 vcc, s46, v130
    v_cmp_gt_u32 s[60:61], s46, v8
    v_add_lshl_u32 v130, v130, s45, 2
    v_add_u32 v8, 64, v130
    v_sub_u32 v131, -40960, v102
    v_cndmask_b32 v28, -1, v130, vcc
    v_cndmask_b32 v29, -1, v8, s[60:61]
    v_add_u32 v130, v130, v102
    v_add_u32 v130, 20480, v130
    s_mov_b32 s4, 0
    s_mov_b32 s5, 30848
    s_mov_b32 s6, 61696
    s_mov_b32 s7, 92544
    s_mov_b32 s8, 123392
    s_mov_b32 s9, 154240
    s_mov_b32 s10, 185088
    s_mov_b32 s11, 215936
    s_lshl_b32 s63, s46, 2
    s_mov_b32 s62, 0
    ds_write_b32 v101, v56 offset:47360
    ds_write_b64 v56, v[56:57] offset:48128
    v_mov_b32 v224, 252
    v_mov_b32 v208, 0
    v_mov_b32 v225, 252
    v_mov_b32 v209, 0
    v_mov_b32 v226, 252
    v_mov_b32 v210, 0
    v_mov_b32 v227, 252
    v_mov_b32 v211, 0
    v_mov_b32 v228, 252
    v_mov_b32 v212, 0
    v_mov_b32 v229, 252
    v_mov_b32 v213, 0
    v_mov_b32 v230, 252
    v_mov_b32 v214, 0
    v_mov_b32 v231, 252
    v_mov_b32 v215, 0
    v_mov_b32 v202, 0
    v_mov_b32 v206, 0
    v_mov_b32 v207, 0
    s_branch K2_begin
    .p2align 6
K2_loopS:
    v_rcp_f32 v198, v36
    v_rcp_f32 v199, v37
    s_setprio 1
    v_exp_f32 v176, v144
    v_exp_f32 v177, v145
    v_exp_f32 v178, v146
    v_exp_f32 v179, v147
    v_exp_f32 v180, v148
    v_exp_f32_e64 v181, v149
    v_mfma_f32_32x32x16_bf16 v[160:175], v[88:91], v[44:47], v[72:87]
    v_exp_f32 v182, v150
    v_exp_f32 v183, v151
    v_exp_f32 v184, v152
    v_exp_f32 v185, v153
    v_exp_f32 v186, v154
    v_exp_f32 v187, v155
    v_exp_f32 v188, v156
    v_exp_f32 v189, v157
    v_exp_f32 v190, v158
    v_exp_f32_e64 v191, v159
    s_cmp_lg_u64 s[78:79], 0
    v_pk_mul_f32 v[192:193], v[192:193], v[196:197]
    v_pk_mul_f32 v[32:33], v[32:33], v[194:195]
    v_pk_fma_f32 v[204:205], v[192:193], v[198:199], v[204:205]
    v_pk_fma_f32 v[206:207], v[32:33], v[198:199], v[206:207]
    v_pk_fma_f32 v[30:31], v[34:35], v[36:37], v[30:31]
    s_waitcnt lgkmcnt(0)
    s_cbranch_scc1 K2_flS0
K2_flrS0:
    buffer_load_dwordx4 v[16:17], s[16:19], s15 idxen offen offset:0 sc1 lds
    buffer_load_dwordx4 v[18:19], s[16:19], s15 idxen offen offset:1024 sc1 lds
    buffer_load_dwordx4 v[20:21], s[16:19], s15 idxen offen offset:2048 sc1 lds
    buffer_load_dwordx4 v[22:23], s[16:19], s15 idxen offen offset:3072 sc1 lds
    s_setprio 0
    s_mov_b32 m0, s52
    v_pk_add_f32 v[176:177], v[176:177], 1.0 op_sel_hi:[1,0]
    v_pk_add_f32 v[178:179], v[178:179], 1.0 op_sel_hi:[1,0]
    v_pk_add_f32 v[180:181], v[180:181], 1.0 op_sel_hi:[1,0]
    v_pk_add_f32 v[182:183], v[182:183], 1.0 op_sel_hi:[1,0]
    v_pk_add_f32 v[184:185], v[184:185], 1.0 op_sel_hi:[1,0]
    v_pk_add_f32 v[186:187], v[186:187], 1.0 op_sel_hi:[1,0]
    v_pk_add_f32 v[188:189], v[188:189], 1.0 op_sel_hi:[1,0]
    v_pk_add_f32 v[190:191], v[190:191], 1.0 op_sel_hi:[1,0]
    v_rcp_f32 v176, v176
    v_rcp_f32 v177, v177
    v_rcp_f32 v178, v178
    v_rcp_f32 v179, v179
    v_rcp_f32 v180, v180
    v_rcp_f32 v181, v181
    v_rcp_f32 v182, v182
    v_rcp_f32 v183, v183
    v_rcp_f32 v184, v184
    v_rcp_f32 v185, v185
    v_rcp_f32 v186, v186
    v_rcp_f32 v187, v187
    v_rcp_f32 v188, v188
    v_rcp_f32 v189, v189
    v_rcp_f32 v190, v190
    v_rcp_f32 v191, v191
    v_mov_b32 v194, 1.0
    v_mov_b32 v195, 1.0
    v_pk_mul_f32 v[192:193], v[144:145], v[176:177]
    v_pk_fma_f32 v[192:193], v[146:147], v[178:179], v[192:193]
    v_pk_fma_f32 v[192:193], v[148:149], v[180:181], v[192:193]
    v_pk_fma_f32 v[192:193], v[150:151], v[182:183], v[192:193]
    v_pk_fma_f32 v[192:193], v[152:153], v[184:185], v[192:193]
    v_pk_fma_f32 v[192:193], v[154:155], v[186:187], v[192:193]
    v_pk_fma_f32 v[192:193], v[156:157], v[188:189], v[192:193]
    v_pk_fma_f32 v[192:193], v[158:159], v[190:191], v[192:193]
    s_setprio 1
    v_exp_f32 v176, v160
    v_exp_f32 v177, v161
    v_exp_f32 v178, v162
    v_exp_f32 v179, v163
    v_exp_f32 v180, v164
    v_exp_f32 v181, v165
    v_exp_f32 v182, v166
    v_exp_f32_e64 v183, v167
    v_mfma_f32_32x32x16_bf16 v[144:159], v[88:91], v[48:51], v[216:231]
    v_exp_f32 v184, v168
    v_exp_f32 v185, v169
    v_exp_f32 v186, v170
    v_exp_f32 v187, v171
    v_exp_f32 v188, v172
    v_exp_f32 v189, v173
    v_exp_f32 v190, v174
    v_exp_f32_e64 v191, v175
    s_waitcnt vmcnt(4)
    ds_read_b64_tr_b16 v[56:57], v12 offset:0
    ds_read_b64_tr_b16 v[58:59], v12 offset:256
    ds_read_b64_tr_b16 v[60:61], v12 offset:1024
    ds_read_b64_tr_b16 v[62:63], v12 offset:1280
    ds_read_b64_tr_b16 v[64:65], v12 offset:2048
    ds_read_b64_tr_b16 v[66:67], v12 offset:2304
    ds_read_b64_tr_b16 v[68:69], v12 offset:3072
    ds_read_b64_tr_b16 v[70:71], v12 offset:3328
    ds_read_b64_tr_b16 v[72:73], v12 offset:64
    ds_read_b64_tr_b16 v[74:75], v12 offset:320
    ds_read_b64_tr_b16 v[76:77], v12 offset:1088
    ds_read_b64_tr_b16 v[78:79], v12 offset:1344
    ds_read_b64_tr_b16 v[80:81], v12 offset:2112
    ds_read_b64_tr_b16 v[82:83], v12 offset:2368
    ds_read_b64_tr_b16 v[84:85], v12 offset:3136
    ds_read_b64_tr_b16 v[86:87], v12 offset:3392
    ds_read_u16 v16, v4 offset:256
    ds_read_u16 v18, v4 offset:288
    ds_read_u16 v20, v4 offset:320
    ds_read_u16 v22, v4 offset:352
    s_setprio 0
    s_add_u32 s51, s51, 1
    v_pk_add_f32 v[176:177], v[176:177], 1.0 op_sel_hi:[1,0]
    v_pk_add_f32 v[178:179], v[178:179], 1.0 op_sel_hi:[1,0]
    v_pk_add_f32 v[180:181], v[180:181], 1.0 op_sel_hi:[1,0]
    v_pk_add_f32 v[182:183], v[182:183], 1.0 op_sel_hi:[1,0]
    v_pk_add_f32 v[184:185], v[184:185], 1.0 op_sel_hi:[1,0]
    v_pk_add_f32 v[186:187], v[186:187], 1.0 op_sel_hi:[1,0]
    v_pk_add_f32 v[188:189], v[188:189], 1.0 op_sel_hi:[1,0]
    v_pk_add_f32 v[190:191], v[190:191], 1.0 op_sel_hi:[1,0]
    v_rcp_f32 v176, v176
    v_rcp_f32 v177, v177
    v_rcp_f32 v178, v178
    v_rcp_f32 v179, v179
    v_rcp_f32 v180, v180
    v_rcp_f32 v181, v181
    v_rcp_f32 v182, v182
    v_rcp_f32 v183, v183
    v_rcp_f32 v184, v184
    v_rcp_f32 v185, v185
    v_rcp_f32 v186, v186
    v_rcp_f32 v187, v187
    v_rcp_f32 v188, v188
    v_rcp_f32 v189, v189
    v_rcp_f32 v190, v190
    v_rcp_f32 v191, v191
    v_mov_b32 v196, 1.0
    v_mov_b32 v197, 1.0
    v_pk_mul_f32 v[32:33], v[160:161], v[176:177]
    v_pk_fma_f32 v[32:33], v[162:163], v[178:179], v[32:33]
    v_pk_fma_f32 v[32:33], v[164:165], v[180:181], v[32:33]
    v_pk_fma_f32 v[32:33], v[166:167], v[182:183], v[32:33]
    v_pk_fma_f32 v[32:33], v[168:169], v[184:185], v[32:33]
    v_pk_fma_f32 v[32:33], v[170:171], v[186:187], v[32:33]
    v_pk_fma_f32 v[32:33], v[172:173], v[188:189], v[32:33]
    v_pk_fma_f32 v[32:33], v[174:175], v[190:191], v[32:33]
    v_pk_mul_f32 v[34:35], v[194:195], v[196:197]
    v_cmp_ne_u32 s[74:75], v96, v14
    v_cmp_ne_u32 s[76:77], v97, v15
    v_rcp_f32 v198, v34
    v_rcp_f32 v199, v35
    s_setprio 1
    v_exp_f32 v176, v144
    v_exp_f32 v177, v145
    v_exp_f32 v178, v146
    v_exp_f32 v179, v147
    v_exp_f32 v180, v148
    v_exp_f32_e64 v181, v149
    v_mfma_f32_32x32x16_bf16 v[160:175], v[88:91], v[52:55], v[232:247]
    v_exp_f32 v182, v150
    v_exp_f32 v183, v151
    v_exp_f32 v184, v152
    v_exp_f32 v185, v153
    v_exp_f32 v186, v154
    v_exp_f32 v187, v155
    v_exp_f32 v188, v156
    v_exp_f32 v189, v157
    v_exp_f32 v190, v158
    v_exp_f32_e64 v191, v159
    s_or_b64 s[78:79], s[74:75], s[76:77]
    v_pk_mul_f32 v[192:193], v[192:193], v[196:197]
    v_pk_mul_f32 v[32:33], v[32:33], v[194:195]
    v_pk_fma_f32 v[200:201], v[192:193], v[198:199], v[200:201]
    v_pk_fma_f32 v[202:203], v[32:33], v[198:199], v[202:203]
    s_waitcnt lgkmcnt(0)
    s_cbranch_scc1 K2_qS0
K2_qrS0:
    buffer_load_dwordx4 v[16:17], s[16:19], 0 idxen offen offset:0 sc1 lds
    buffer_load_dwordx4 v[18:19], s[16:19], 0 idxen offen offset:1024 sc1 lds
    buffer_load_dwordx4 v[20:21], s[16:19], 0 idxen offen offset:2048 sc1 lds
    buffer_load_dwordx4 v[22:23], s[16:19], 0 idxen offen offset:3072 sc1 lds
    s_setprio 0
    s_mov_b32 m0, s14
    v_pk_add_f32 v[176:177], v[176:177], 1.0 op_sel_hi:[1,0]
    v_pk_add_f32 v[178:179], v[178:179], 1.0 op_sel_hi:[1,0]
    v_pk_add_f32 v[180:181], v[180:181], 1.0 op_sel_hi:[1,0]
    v_pk_add_f32 v[182:183], v[182:183], 1.0 op_sel_hi:[1,0]
    v_pk_add_f32 v[184:185], v[184:185], 1.0 op_sel_hi:[1,0]
    v_pk_add_f32 v[186:187], v[186:187], 1.0 op_sel_hi:[1,0]
    v_pk_add_f32 v[188:189], v[188:189], 1.0 op_sel_hi:[1,0]
    v_pk_add_f32 v[190:191], v[190:191], 1.0 op_sel_hi:[1,0]
    v_rcp_f32 v176, v176
    v_rcp_f32 v177, v177
    v_rcp_f32 v178, v178
    v_rcp_f32 v179, v179
    v_rcp_f32 v180, v180
    v_rcp_f32 v181, v181
    v_rcp_f32 v182, v182
    v_rcp_f32 v183, v183
    v_rcp_f32 v184, v184
    v_rcp_f32 v185, v185
    v_rcp_f32 v186, v186
    v_rcp_f32 v187, v187
    v_rcp_f32 v188, v188
    v_rcp_f32 v189, v189
    v_rcp_f32 v190, v190
    v_rcp_f32 v191, v191
    v_mov_b32 v194, 1.0
    v_mov_b32 v195, 1.0
    v_pk_mul_f32 v[192:193], v[144:145], v[176:177]
    v_pk_fma_f32 v[192:193], v[146:147], v[178:179], v[192:193]
    v_pk_fma_f32 v[192:193], v[148:149], v[180:181], v[192:193]
    v_pk_fma_f32 v[192:193], v[150:151], v[182:183], v[192:193]
    v_pk_fma_f32 v[192:193], v[152:153], v[184:185], v[192:193]
    v_pk_fma_f32 v[192:193], v[154:155], v[186:187], v[192:193]
    v_pk_fma_f32 v[192:193], v[156:157], v[188:189], v[192:193]
    v_pk_fma_f32 v[192:193], v[158:159], v[190:191], v[192:193]
    s_setprio 1
    v_exp_f32 v176, v160
    v_exp_f32 v177, v161
    v_exp_f32 v178, v162
    v_exp_f32 v179, v163
    v_exp_f32 v180, v164
    v_exp_f32 v181, v165
    v_exp_f32 v182, v166
    v_exp_f32 v183, v167
    s_waitcnt lgkmcnt(0)
    v_mfma_f32_32x32x16_bf16 v[144:159], v[92:95], v[40:43], v[56:71]
    v_exp_f32 v184, v168
    v_exp_f32 v185, v169
    v_exp_f32 v186, v170
    v_exp_f32 v187, v171
    v_exp_f32 v188, v172
    v_exp_f32 v189, v173
    v_exp_f32 v190, v174
    v_exp_f32_e64 v191, v175
    s_waitcnt vmcnt(4)
    ds_read_b64_tr_b16 v[216:217], v12 offset:4096
    ds_read_b64_tr_b16 v[218:219], v12 offset:4352
    ds_read_b64_tr_b16 v[220:221], v12 offset:5120
    ds_read_b64_tr_b16 v[222:223], v12 offset:5376
    ds_read_b64_tr_b16 v[224:225], v12 offset:6144
    ds_read_b64_tr_b16 v[226:227], v12 offset:6400
    ds_read_b64_tr_b16 v[228:229], v12 offset:7168
    ds_read_b64_tr_b16 v[230:231], v12 offset:7424
    ds_read_b64_tr_b16 v[232:233], v12 offset:4160
    ds_read_b64_tr_b16 v[234:235], v12 offset:4416
    ds_read_b64_tr_b16 v[236:237], v12 offset:5184
    ds_read_b64_tr_b16 v[238:239], v12 offset:5440
    ds_read_b64_tr_b16 v[240:241], v12 offset:6208
    ds_read_b64_tr_b16 v[242:243], v12 offset:6464
    ds_read_b64_tr_b16 v[244:245], v12 offset:7232
    ds_read_b64_tr_b16 v[246:247], v12 offset:7488
    ds_read_u16 v96, v5 offset:256
    ds_read_u16 v97, v6 offset:256
    ds_read_b64 v[88:89], v3 offset:256
    s_mov_b64 exec, s[56:57]
    ds_read_b32 v90, v3 offset:268
    s_mov_b64 exec, s[58:59]
    ds_read_b32 v91, v3 offset:268
    s_mov_b64 exec, -1
    s_setprio 0
    v_pk_add_f32 v[176:177], v[176:177], 1.0 op_sel_hi:[1,0]
    v_pk_add_f32 v[178:179], v[178:179], 1.0 op_sel_hi:[1,0]
    v_pk_add_f32 v[180:181], v[180:181], 1.0 op_sel_hi:[1,0]
    v_pk_add_f32 v[182:183], v[182:183], 1.0 op_sel_hi:[1,0]
    v_pk_add_f32 v[184:185], v[184:185], 1.0 op_sel_hi:[1,0]
    v_pk_add_f32 v[186:187], v[186:187], 1.0 op_sel_hi:[1,0]
    v_pk_add_f32 v[188:189], v[188:189], 1.0 op_sel_hi:[1,0]
    v_pk_add_f32 v[190:191], v[190:191], 1.0 op_sel_hi:[1,0]
    v_rcp_f32 v176, v176
    v_rcp_f32 v177, v177
    v_rcp_f32 v178, v178
    v_rcp_f32 v179, v179
    v_rcp_f32 v180, v180
    v_rcp_f32 v181, v181
    v_rcp_f32 v182, v182
    v_rcp_f32 v183, v183
    v_rcp_f32 v184, v184
    v_rcp_f32 v185, v185
    v_rcp_f32 v186, v186
    v_rcp_f32 v187, v187
    v_rcp_f32 v188, v188
    v_rcp_f32 v189, v189
    v_rcp_f32 v190, v190
    v_rcp_f32 v191, v191
    v_mov_b32 v196, 1.0
    v_mov_b32 v197, 1.0
    v_pk_mul_f32 v[32:33], v[160:161], v[176:177]
    v_pk_fma_f32 v[32:33], v[162:163], v[178:179], v[32:33]
    v_pk_fma_f32 v[32:33], v[164:165], v[180:181], v[32:33]
    v_pk_fma_f32 v[32:33], v[166:167], v[182:183], v[32:33]
    v_pk_fma_f32 v[32:33], v[168:169], v[184:185], v[32:33]
    v_pk_fma_f32 v[32:33], v[170:171], v[186:187], v[32:33]
    v_pk_fma_f32 v[32:33], v[172:173], v[188:189], v[32:33]
    v_pk_fma_f32 v[32:33], v[174:175], v[190:191], v[32:33]
    v_pk_mul_f32 v[36:37], v[194:195], v[196:197]
    s_cmp_lt_u32 s51, s50
    s_cbranch_scc0 K2_tail
    v_rcp_f32 v198, v36
    v_rcp_f32 v199, v37
    s_setprio 1
    v_exp_f32 v176, v144
    v_exp_f32 v177, v145
    v_exp_f32 v178, v146
    v_exp_f32 v179, v147
    v_exp_f32 v180, v148
    v_exp_f32_e64 v181, v149
    v_mfma_f32_32x32x16_bf16 v[160:175], v[92:95], v[44:47], v[72:87]
    v_exp_f32 v182, v150
    v_exp_f32 v183, v151
    v_exp_f32 v184, v152
    v_exp_f32 v185, v153
    v_exp_f32 v186, v154
    v_exp_f32 v187, v155
    v_exp_f32 v188, v156
    v_exp_f32 v189, v157
    v_exp_f32 v190, v158
    v_exp_f32_e64 v191, v159
    s_cmp_lg_u64 s[78:79], 0
    v_pk_mul_f32 v[192:193], v[192:193], v[196:197]
    v_pk_mul_f32 v[32:33], v[32:33], v[194:195]
    v_pk_fma_f32 v[204:205], v[192:193], v[198:199], v[204:205]
    v_pk_fma_f32 v[206:207], v[32:33], v[198:199], v[206:207]
    v_pk_fma_f32 v[30:31], v[34:35], v[36:37], v[30:31]
    s_waitcnt lgkmcnt(0)
    s_cbranch_scc1 K2_flS1
K2_flrS1:
    buffer_load_dwordx4 v[16:17], s[16:19], s15 idxen offen offset:0 sc1 lds
    buffer_load_dwordx4 v[18:19], s[16:19], s15 idxen offen offset:1024 sc1 lds
    buffer_load_dwordx4 v[20:21], s[16:19], s15 idxen offen offset:2048 sc1 lds
    buffer_load_dwordx4 v[22:23], s[16:19], s15 idxen offen offset:3072 sc1 lds
    s_setprio 0
    s_mov_b32 m0, s52
    v_pk_add_f32 v[176:177], v[176:177], 1.0 op_sel_hi:[1,0]
    v_pk_add_f32 v[178:179], v[178:179], 1.0 op_sel_hi:[1,0]
    v_pk_add_f32 v[180:181], v[180:181], 1.0 op_sel_hi:[1,0]
    v_pk_add_f32 v[182:183], v[182:183], 1.0 op_sel_hi:[1,0]
    v_pk_add_f32 v[184:185], v[184:185], 1.0 op_sel_hi:[1,0]
    v_pk_add_f32 v[186:187], v[186:187], 1.0 op_sel_hi:[1,0]
    v_pk_add_f32 v[188:189], v[188:189], 1.0 op_sel_hi:[1,0]
    v_pk_add_f32 v[190:191], v[190:191], 1.0 op_sel_hi:[1,0]
    v_rcp_f32 v176, v176
    v_rcp_f32 v177, v177
    v_rcp_f32 v178, v178
    v_rcp_f32 v179, v179
    v_rcp_f32 v180, v180
    v_rcp_f32 v181, v181
    v_rcp_f32 v182, v182
    v_rcp_f32 v183, v183
    v_rcp_f32 v184, v184
    v_rcp_f32 v185, v185
    v_rcp_f32 v186, v186
    v_rcp_f32 v187, v187
    v_rcp_f32 v188, v188
    v_rcp_f32 v189, v189
    v_rcp_f32 v190, v190
    v_rcp_f32 v191, v191
    v_mov_b32 v194, 1.0
    v_mov_b32 v195, 1.0
    v_pk_mul_f32 v[192:193], v[144:145], v[176:177]
    v_pk_fma_f32 v[192:193], v[146:147], v[178:179], v[192:193]
    v_pk_fma_f32 v[192:193], v[148:149], v[180:181], v[192:193]
    v_pk_fma_f32 v[192:193], v[150:151], v[182:183], v[192:193]
    v_pk_fma_f32 v[192:193], v[152:153], v[184:185], v[192:193]
    v_pk_fma_f32 v[192:193], v[154:155], v[186:187], v[192:193]
    v_pk_fma_f32 v[192:193], v[156:157], v[188:189], v[192:193]
    v_pk_fma_f32 v[192:193], v[158:159], v[190:191], v[192:193]
    s_setprio 1
    v_exp_f32 v176, v160
    v_exp_f32 v177, v161
    v_exp_f32 v178, v162
    v_exp_f32 v179, v163
    v_exp_f32 v180, v164
    v_exp_f32 v181, v165
    v_exp_f32 v182, v166
    v_exp_f32_e64 v183, v167
    v_mfma_f32_32x32x16_bf16 v[144:159], v[92:95], v[48:51], v[216:231]
    v_exp_f32 v184, v168
    v_exp_f32 v185, v169
    v_exp_f32 v186, v170
    v_exp_f32 v187, v171
    v_exp_f32 v188, v172
    v_exp_f32 v189, v173
    v_exp_f32 v190, v174
    v_exp_f32_e64 v191, v175
    s_waitcnt vmcnt(4)
    ds_read_b64_tr_b16 v[56:57], v12 offset:0
    ds_read_b64_tr_b16 v[58:59], v12 offset:256
    ds_read_b64_tr_b16 v[60:61], v12 offset:1024
    ds_read_b64_tr_b16 v[62:63], v12 offset:1280
    ds_read_b64_tr_b16 v[64:65], v12 offset:2048
    ds_read_b64_tr_b16 v[66:67], v12 offset:2304
    ds_read_b64_tr_b16 v[68:69], v12 offset:3072
    ds_read_b64_tr_b16 v[70:71], v12 offset:3328
    ds_read_b64_tr_b16 v[72:73], v12 offset:64
    ds_read_b64_tr_b16 v[74:75], v12 offset:320
    ds_read_b64_tr_b16 v[76:77], v12 offset:1088
    ds_read_b64_tr_b16 v[78:79], v12 offset:1344
    ds_read_b64_tr_b16 v[80:81], v12 offset:2112
    ds_read_b64_tr_b16 v[82:83], v12 offset:2368
    ds_read_b64_tr_b16 v[84:85], v12 offset:3136
    ds_read_b64_tr_b16 v[86:87], v12 offset:3392
    ds_read_u16 v16, v4 offset:384
    ds_read_u16 v18, v4 offset:416
    ds_read_u16 v20, v4 offset:448
    ds_read_u16 v22, v4 offset:480
    s_setprio 0
    s_add_u32 s51, s51, 1
    v_pk_add_f32 v[176:177], v[176:177], 1.0 op_sel_hi:[1,0]
    v_pk_add_f32 v[178:179], v[178:179], 1.0 op_sel_hi:[1,0]
    v_pk_add_f32 v[180:181], v[180:181], 1.0 op_sel_hi:[1,0]
    v_pk_add_f32 v[182:183], v[182:183], 1.0 op_sel_hi:[1,0]
    v_pk_add_f32 v[184:185], v[184:185], 1.0 op_sel_hi:[1,0]
    v_pk_add_f32 v[186:187], v[186:187], 1.0 op_sel_hi:[1,0]
    v_pk_add_f32 v[188:189], v[188:189], 1.0 op_sel_hi:[1,0]
    v_pk_add_f32 v[190:191], v[190:191], 1.0 op_sel_hi:[1,0]
    v_rcp_f32 v176, v176
    v_rcp_f32 v177, v177
    v_rcp_f32 v178, v178
    v_rcp_f32 v179, v179
    v_rcp_f32 v180, v180
    v_rcp_f32 v181, v181
    v_rcp_f32 v182, v182
    v_rcp_f32 v183, v183
    v_rcp_f32 v184, v184
    v_rcp_f32 v185, v185
    v_rcp_f32 v186, v186
    v_rcp_f32 v187, v187
    v_rcp_f32 v188, v188
    v_rcp_f32 v189, v189
    v_rcp_f32 v190, v190
    v_rcp_f32 v191, v191
    v_mov_b32 v196, 1.0
    v_mov_b32 v197, 1.0
    v_pk_mul_f32 v[32:33], v[160:161], v[176:177]
    v_pk_fma_f32 v[32:33], v[162:163], v[178:179], v[32:33]
    v_pk_fma_f32 v[32:33], v[164:165], v[180:181], v[32:33]
    v_pk_fma_f32 v[32:33], v[166:167], v[182:183], v[32:33]
    v_pk_fma_f32 v[32:33], v[168:169], v[184:185], v[32:33]
    v_pk_fma_f32 v[32:33], v[170:171], v[186:187], v[32:33]
    v_pk_fma_f32 v[32:33], v[172:173], v[188:189], v[32:33]
    v_pk_fma_f32 v[32:33], v[174:175], v[190:191], v[32:33]
    v_pk_mul_f32 v[34:35], v[194:195], v[196:197]
    v_cmp_ne_u32 s[74:75], v96, v14
    v_cmp_ne_u32 s[76:77], v97, v15
    v_rcp_f32 v198, v34
    v_rcp_f32 v199, v35
    s_setprio 1
    v_exp_f32 v176, v144
    v_exp_f32 v177, v145
    v_exp_f32 v178, v146
    v_exp_f32 v179, v147
    v_exp_f32 v180, v148
    v_exp_f32_e64 v181, v149
    v_mfma_f32_32x32x16_bf16 v[160:175], v[92:95], v[52:55], v[232:247]
    v_exp_f32 v182, v150
    v_exp_f32 v183, v151
    v_exp_f32 v184, v152
    v_exp_f32 v185, v153
    v_exp_f32 v186, v154
    v_exp_f32 v187, v155
    v_exp_f32 v188, v156
    v_exp_f32 v189, v157
    v_exp_f32 v190, v158
    v_exp_f32_e64 v191, v159
    s_or_b64 s[78:79], s[74:75], s[76:77]
    v_pk_mul_f32 v[192:193], v[192:193], v[196:197]
    v_pk_mul_f32 v[32:33], v[32:33], v[194:195]
    v_pk_fma_f32 v[200:201], v[192:193], v[198:199], v[200:201]
    v_pk_fma_f32 v[202:203], v[32:33], v[198:199], v[202:203]
    s_waitcnt lgkmcnt(0)
    s_cbranch_scc1 K2_qS1
K2_qrS1:
    buffer_load_dwordx4 v[16:17], s[16:19], 0 idxen offen offset:0 sc1 lds
    buffer_load_dwordx4 v[18:19], s[16:19], 0 idxen offen offset:1024 sc1 lds
    buffer_load_dwordx4 v[20:21], s[16:19], 0 idxen offen offset:2048 sc1 lds
    buffer_load_dwordx4 v[22:23], s[16:19], 0 idxen offen offset:3072 sc1 lds
    s_setprio 0
    s_mov_b32 m0, s14
    v_pk_add_f32 v[176:177], v[176:177], 1.0 op_sel_hi:[1,0]
    v_pk_add_f32 v[178:179], v[178:179], 1.0 op_sel_hi:[1,0]
    v_pk_add_f32 v[180:181], v[180:181], 1.0 op_sel_hi:[1,0]
    v_pk_add_f32 v[182:183], v[182:183], 1.0 op_sel_hi:[1,0]
    v_pk_add_f32 v[184:185], v[184:185], 1.0 op_sel_hi:[1,0]
    v_pk_add_f32 v[186:187], v[186:187], 1.0 op_sel_hi:[1,0]
    v_pk_add_f32 v[188:189], v[188:189], 1.0 op_sel_hi:[1,0]
    v_pk_add_f32 v[190:191], v[190:191], 1.0 op_sel_hi:[1,0]
    v_rcp_f32 v176, v176
    v_rcp_f32 v177, v177
    v_rcp_f32 v178, v178
    v_rcp_f32 v179, v179
    v_rcp_f32 v180, v180
    v_rcp_f32 v181, v181
    v_rcp_f32 v182, v182
    v_rcp_f32 v183, v183
    v_rcp_f32 v184, v184
    v_rcp_f32 v185, v185
    v_rcp_f32 v186, v186
    v_rcp_f32 v187, v187
    v_rcp_f32 v188, v188
    v_rcp_f32 v189, v189
    v_rcp_f32 v190, v190
    v_rcp_f32 v191, v191
    v_mov_b32 v194, 1.0
    v_mov_b32 v195, 1.0
    v_pk_mul_f32 v[192:193], v[144:145], v[176:177]
    v_pk_fma_f32 v[192:193], v[146:147], v[178:179], v[192:193]
    v_pk_fma_f32 v[192:193], v[148:149], v[180:181], v[192:193]
    v_pk_fma_f32 v[192:193], v[150:151], v[182:183], v[192:193]
    v_pk_fma_f32 v[192:193], v[152:153], v[184:185], v[192:193]
    v_pk_fma_f32 v[192:193], v[154:155], v[186:187], v[192:193]
    v_pk_fma_f32 v[192:193], v[156:157], v[188:189], v[192:193]
    v_pk_fma_f32 v[192:193], v[158:159], v[190:191], v[192:193]
    s_setprio 1
    v_exp_f32 v176, v160
    v_exp_f32 v177, v161
    v_exp_f32 v178, v162
    v_exp_f32 v179, v163
    v_exp_f32 v180, v164
    v_exp_f32 v181, v165
    v_exp_f32 v182, v166
    v_exp_f32 v183, v167
    s_waitcnt lgkmcnt(0)
    v_mfma_f32_32x32x16_bf16 v[144:159], v[88:91], v[40:43], v[56:71]
    v_exp_f32 v184, v168
    v_exp_f32 v185, v169
    v_exp_f32 v186, v170
    v_exp_f32 v187, v171
    v_exp_f32 v188, v172
    v_exp_f32 v189, v173
    v_exp_f32 v190, v174
    v_exp_f32_e64 v191, v175
    s_waitcnt vmcnt(4)
    ds_read_b64_tr_b16 v[216:217], v12 offset:4096
    ds_read_b64_tr_b16 v[218:219], v12 offset:4352
    ds_read_b64_tr_b16 v[220:221], v12 offset:5120
    ds_read_b64_tr_b16 v[222:223], v12 offset:5376
    ds_read_b64_tr_b16 v[224:225], v12 offset:6144
    ds_read_b64_tr_b16 v[226:227], v12 offset:6400
    ds_read_b64_tr_b16 v[228:229], v12 offset:7168
    ds_read_b64_tr_b16 v[230:231], v12 offset:7424
    ds_read_b64_tr_b16 v[232:233], v12 offset:4160
    ds_read_b64_tr_b16 v[234:235], v12 offset:4416
    ds_read_b64_tr_b16 v[236:237], v12 offset:5184
    ds_read_b64_tr_b16 v[238:239], v12 offset:5440
    ds_read_b64_tr_b16 v[240:241], v12 offset:6208
    ds_read_b64_tr_b16 v[242:243], v12 offset:6464
    ds_read_b64_tr_b16 v[244:245], v12 offset:7232
    ds_read_b64_tr_b16 v[246:247], v12 offset:7488
    ds_read_u16 v14, v5 offset:384
    ds_read_u16 v15, v6 offset:384
    ds_read_b64 v[92:93], v3 offset:384
    s_mov_b64 exec, s[56:57]
    ds_read_b32 v94, v3 offset:396
    s_mov_b64 exec, s[58:59]
    ds_read_b32 v95, v3 offset:396
    s_mov_b64 exec, -1
    s_setprio 0
    v_pk_add_f32 v[176:177], v[176:177], 1.0 op_sel_hi:[1,0]
    v_pk_add_f32 v[178:179], v[178:179], 1.0 op_sel_hi:[1,0]
    v_pk_add_f32 v[180:181], v[180:181], 1.0 op_sel_hi:[1,0]
    v_pk_add_f32 v[182:183], v[182:183], 1.0 op_sel_hi:[1,0]
    v_pk_add_f32 v[184:185], v[184:185], 1.0 op_sel_hi:[1,0]
    v_pk_add_f32 v[186:187], v[186:187], 1.0 op_sel_hi:[1,0]
    v_pk_add_f32 v[188:189], v[188:189], 1.0 op_sel_hi:[1,0]
    v_pk_add_f32 v[190:191], v[190:191], 1.0 op_sel_hi:[1,0]
    v_rcp_f32 v176, v176
    v_rcp_f32 v177, v177
    v_rcp_f32 v178, v178
    v_rcp_f32 v179, v179
    v_rcp_f32 v180, v180
    v_rcp_f32 v181, v181
    v_rcp_f32 v182, v182
    v_rcp_f32 v183, v183
    v_rcp_f32 v184, v184
    v_rcp_f32 v185, v185
    v_rcp_f32 v186, v186
    v_rcp_f32 v187, v187
    v_rcp_f32 v188, v188
    v_rcp_f32 v189, v189
    v_rcp_f32 v190, v190
    v_rcp_f32 v191, v191
    v_mov_b32 v196, 1.0
    v_mov_b32 v197, 1.0
    v_pk_mul_f32 v[32:33], v[160:161], v[176:177]
    v_pk_fma_f32 v[32:33], v[162:163], v[178:179], v[32:33]
    v_pk_fma_f32 v[32:33], v[164:165], v[180:181], v[32:33]
    v_pk_fma_f32 v[32:33], v[166:167], v[182:183], v[32:33]
    v_pk_fma_f32 v[32:33], v[168:169], v[184:185], v[32:33]
    v_pk_fma_f32 v[32:33], v[170:171], v[186:187], v[32:33]
    v_pk_fma_f32 v[32:33], v[172:173], v[188:189], v[32:33]
    v_pk_fma_f32 v[32:33], v[174:175], v[190:191], v[32:33]
    v_pk_mul_f32 v[36:37], v[194:195], v[196:197]
    v_add_u32 v3, 0x100, v3
    v_add_u32 v4, 0x100, v4
    v_add_u32 v5, 0x100, v5
    v_add_u32 v6, 0x100, v6
    s_cmp_lt_u32 s51, s50
    s_cbranch_scc1 K2_loopS
    s_branch K2_tail
    .p2align 3
K2_flS0:
    s_mov_b64 exec, s[74:75]
    s_cbranch_execz K2_fsS0
    ds_write2_b32 v26, v200, v202 offset0:0 offset1:32
    ds_write2_b32 v26, v204, v206 offset0:64 offset1:96
    v_mov_b32 v200, 0
    v_mov_b32 v202, 0
    v_mov_b32 v204, 0
    v_mov_b32 v206, 0
    v_lshl_add_u32 v26, v24, 1, v11
    s_mov_b64 exec, -1
    s_cmp_eq_u64 s[76:77], 0
    s_cbranch_scc1 K2_flrS0
K2_fsS0:
    s_mov_b64 exec, s[76:77]
    ds_write2_b32 v27, v201, v203 offset0:128 offset1:160
    ds_write2_b32 v27, v205, v207 offset0:192 offset1:224
    v_mov_b32 v201, 0
    v_mov_b32 v203, 0
    v_mov_b32 v205, 0
    v_mov_b32 v207, 0
    v_lshl_add_u32 v27, v25, 1, v11
    s_mov_b64 exec, -1
    s_branch K2_flrS0
    .p2align 3
K2_qS0:
    s_cmp_eq_u64 s[74:75], 0
    s_cbranch_scc1 K2_qsS0
    v_lshl_add_u32 v24, v14, 6, v251
    ds_read_u16_d16_hi v42, v24 offset:0
    ds_read_u16_d16_hi v46, v24 offset:64
    ds_read_u16_d16_hi v50, v24 offset:128
    ds_read_u16_d16_hi v54, v24 offset:192
K2_qsS0:
    s_cmp_eq_u64 s[76:77], 0
    s_cbranch_scc1 K2_qrS0
    v_lshl_add_u32 v25, v15, 6, v251
    ds_read_u16_d16_hi v43, v25 offset:0
    ds_read_u16_d16_hi v47, v25 offset:64
    ds_read_u16_d16_hi v51, v25 offset:128
    ds_read_u16_d16_hi v55, v25 offset:192
    s_branch K2_qrS0
    .p2align 3
K2_flS1:
    s_mov_b64 exec, s[74:75]
    s_cbranch_execz K2_fsS1
    ds_write2_b32 v26, v200, v202 offset0:0 offset1:32
    ds_write2_b32 v26, v204, v206 offset0:64 offset1:96
    v_mov_b32 v200, 0
    v_mov_b32 v202, 0
    v_mov_b32 v204, 0
    v_mov_b32 v206, 0
    v_lshl_add_u32 v26, v24, 1, v11
    s_mov_b64 exec, -1
    s_cmp_eq_u64 s[76:77], 0
    s_cbranch_scc1 K2_flrS1
K2_fsS1:
    s_mov_b64 exec, s[76:77]
    ds_write2_b32 v27, v201, v203 offset0:128 offset1:160
    ds_write2_b32 v27, v205, v207 offset0:192 offset1:224
    v_mov_b32 v201, 0
    v_mov_b32 v203, 0
    v_mov_b32 v205, 0
    v_mov_b32 v207, 0
    v_lshl_add_u32 v27, v25, 1, v11
    s_mov_b64 exec, -1
    s_branch K2_flrS1
    .p2align 3
K2_qS1:
    s_cmp_eq_u64 s[74:75], 0
    s_cbranch_scc1 K2_qsS1
    v_lshl_add_u32 v24, v96, 6, v251
    ds_read_u16_d16_hi v42, v24 offset:0
    ds_read_u16_d16_hi v46, v24 offset:64
    ds_read_u16_d16_hi v50, v24 offset:128
    ds_read_u16_d16_hi v54, v24 offset:192
K2_qsS1:
    s_cmp_eq_u64 s[76:77], 0
    s_cbranch_scc1 K2_qrS1
    v_lshl_add_u32 v25, v97, 6, v251
    ds_read_u16_d16_hi v43, v25 offset:0
    ds_read_u16_d16_hi v47, v25 offset:64
    ds_read_u16_d16_hi v51, v25 offset:128
    ds_read_u16_d16_hi v55, v25 offset:192
    s_branch K2_qrS1
.section .rodata,"a"
.p2align 6
.amdhsa_kernel gather_scatter__edge_featured_mpnn_mpnn__graph_kernel
  .amdhsa_next_free_vgpr 252
  .amdhsa_next_free_sgpr 100
  .amdhsa_accum_offset 252
  .amdhsa_group_segment_fixed_size 0
  .amdhsa_kernarg_size 88
  .amdhsa_user_sgpr_count 2
  .amdhsa_user_sgpr_kernarg_segment_ptr 1
  .amdhsa_system_sgpr_workgroup_id_x 1
.end_amdhsa_kernel
```
